```python
import torch

def _softmax(x, axis=-1):
    return torch.softmax(x, dim=axis)
def _gelu(x):
    return torch.nn.functional.gelu(x, approximate="tanh")
def _silu(x):
    return torch.nn.functional.silu(x)
def _sigmoid(x):
    return torch.sigmoid(x)
def _layernorm(x, axis=-1, eps=1e-5):
    m = x.mean(dim=axis, keepdim=True)
    v = x.var(dim=axis, keepdim=True, unbiased=False)
    return (x - m) / torch.sqrt(v + eps)
def _scatter_add(tgt, idx, src, axis=0):
    return tgt.clone().index_add_(axis, idx, src)
def _segment_sum(src, seg, n):
    out = torch.zeros((n,) + src.shape[1:], dtype=src.dtype)
    return out.index_add_(0, seg, src)
def _pad(x, pw):
    flat = tuple(v for pair in reversed(pw) for v in pair)
    return torch.nn.functional.pad(x, flat)

kernel_name = 'gated_mix__sliding_block__dense_activation_relu__prompt'

def setup_inputs():

    _w = (lambda a: (lambda t: t.to(torch.bfloat16) if t.is_floating_point() else t)(torch.as_tensor(a)))
    def _A_setup():
        B, S, D = 1, 2048, 448
        return {
            "x": _w((lambda *s: torch.randn(*s, dtype=torch.bfloat16) * 0.05)(B, S, D)),
            "wqkv": _w((lambda *s: torch.randn(*s, dtype=torch.bfloat16) * 1.6)(D, 3 * D)),
            "wo": _w((lambda *s: torch.randn(*s, dtype=torch.bfloat16) * 0.05)(D, D)),
        }
    _A_in = _A_setup()

    def _B_setup():
        B, S, D, Dff = 1, 2048, 448, 1792
        return {
            "x": _w((lambda *s: torch.randn(*s, dtype=torch.bfloat16) * 0.05)(B, S, D)),
            "w1": _w((lambda *s: torch.randn(*s, dtype=torch.bfloat16) * 0.2)(D, Dff)),
            "w2": _w((lambda *s: torch.randn(*s, dtype=torch.bfloat16) * 0.2)(Dff, D)),
        }
    _B_in = _B_setup()

    return {
        "A_x": _A_in["x"],
        "A_wqkv": _A_in["wqkv"],
        "A_wo": _A_in["wo"],
        "B_x": _B_in["x"],
        "B_w1": _B_in["w1"],
        "B_w2": _B_in["w2"],
        "gate_w": _w((lambda *s: torch.randn(*s, dtype=torch.bfloat16) * 0.05)(448) * 16.0),
    }

def reference(A_x, A_wqkv, A_wo, B_x, B_w1, B_w2, gate_w):
    def _A_ref(x, wqkv, wo):
        B, S, D = x.shape
        H = 16; Dh = D // H; W = 256
        qkv = (lambda x, *d: x.permute(*d))((x @ wqkv).reshape(B, S, 3, H, Dh), 2, 0, 3, 1, 4)
        q, k, v = qkv[0], qkv[1], qkv[2]
        scores = torch.einsum("bhqd,bhkd->bhqk", q, k) * (Dh ** -0.5)
        idx = torch.arange(S)
        mask = (idx[:, None] - idx[None, :] >= 0) & (idx[:, None] - idx[None, :] < W)
        scores = torch.where(mask[None, None], scores, -1e9)
        p = _softmax(scores, axis=-1)
        o = torch.einsum("bhqk,bhkd->bhqd", p, v)
        return (lambda x, *d: x.permute(*d))(o, 0, 2, 1, 3).reshape(B, S, D) @ wo

    def _B_ref(x, w1, w2):
        h = torch.einsum("bsd,df->bsf", x, w1)
        zero = torch.zeros_like(h)
        h = torch.maximum(h, zero)
        return torch.einsum("bsf,fd->bsd", h, w2)

    x = A_x
    g = _sigmoid((x * gate_w).sum(-1, keepdims=True))
    a = _A_ref(x, A_wqkv, A_wo)
    b = _B_ref(x, B_w1, B_w2)
    return g * a + (1 - g) * b
```

```asm
; @launch grid=(256,1,1) block=(512,1,1) lds=163840
.amdgcn_target "amdgcn-amd-amdhsa--gfx950"
.text
.globl gated_mix__sliding_block__dense_activation_relu__prompt_kernel
.p2align 8
.type gated_mix__sliding_block__dense_activation_relu__prompt_kernel,@function
gated_mix__sliding_block__dense_activation_relu__prompt_kernel:
    s_cmp_ge_u32 s2, 256
    s_cbranch_scc1 L_end
    s_load_dwordx16 s[64:79], s[0:1], 0
    s_load_dwordx4 s[80:83], s[0:1], 64
    s_getpc_b64 s[4:5]
    v_lshlrev_b32 v33, 7, v0
    v_cmp_gt_u32 vcc, 0x4804, v33
    s_nop 0
    s_and_saveexec_b64 s[6:7], vcc
    s_cbranch_execz L_nopf
    global_load_dword v252, v33, s[4:5]
L_nopf:
    s_mov_b64 exec, -1
    v_and_b32 v1, 63, v0
    v_lshrrev_b32 v33, 6, v0
    v_lshlrev_b32 v2, 4, v1
    v_readfirstlane_b32 s40, v33
    s_and_b32 s4, s2, 7
    s_lshr_b32 s44, s2, 3
    s_lshr_b32 s5, s4, 1
    s_and_b32 s54, s5, 1
    s_lshl_b32 s54, s54, 2
    s_add_u32 s54, s54, s44
    s_and_b32 s54, s54, 7
    s_and_b32 s55, s4, 1
    s_lshl_b32 s55, s55, 3
    s_add_u32 s42, s54, s55
    s_lshr_b32 s55, s44, 3
    s_lshl_b32 s43, s5, 2
    s_add_u32 s43, s43, s55
    s_lshl_b32 s55, s55, 1
    s_add_u32 s54, s54, s55
    s_sub_u32 s55, s54, 7
    s_cselect_b32 s54, s54, s55
    s_lshl_b32 s45, s54, 7
    s_mul_i32 s52, s42, 114688
    s_lshl_b32 s41, s40, 10
    s_lshl_b32 s56, s43, 7
    v_lshrrev_b32 v33, 3, v0
    v_and_b32 v34, 7, v0
    v_and_b32 v35, 6, v33
    v_xor_b32 v35, v35, v34
    v_mul_u32_u24 v3, 896, v33
    v_lshl_add_u32 v3, v35, 4, v3
    v_lshrrev_b32 v36, 1, v33
    v_and_b32 v36, 4, v36
    v_and_or_b32 v36, v33, 2, v36
    v_xor_b32 v36, v36, v34
    v_lshl_add_u32 v36, v36, 4, s56
    v_mul_u32_u24 v4, 2688, v33
    v_add_u32 v4, v4, v36
    v_mul_u32_u24 v5, 3584, v33
    v_add_u32 v5, v5, v36
    s_add_u32 s46, s45, 128
    s_cmp_ge_u32 s46, 896
    s_cselect_b32 s46, 0, s46
    s_add_u32 s47, s46, 128
    s_cmp_ge_u32 s47, 896
    s_cselect_b32 s47, 0, s47
    s_add_u32 s48, s47, 128
    s_cmp_ge_u32 s48, 896
    s_cselect_b32 s48, 0, s48
    s_add_u32 s49, s48, 128
    s_cmp_ge_u32 s49, 896
    s_cselect_b32 s49, 0, s49
    s_add_u32 s50, s49, 128
    s_cmp_ge_u32 s50, 896
    s_cselect_b32 s50, 0, s50
    s_add_u32 s51, s50, 128
    s_cmp_ge_u32 s51, 896
    s_cselect_b32 s51, 0, s51
    s_mov_b32 s10, 1835008
    s_mov_b32 s11, 0x20000
    s_mov_b32 s14, 1204224
    s_mov_b32 s15, 0x20000
    s_mov_b32 s18, 1605632
    s_mov_b32 s19, 0x20000
    s_waitcnt lgkmcnt(0)
    s_mov_b64 s[8:9], s[64:65]
    s_mov_b64 s[12:13], s[66:67]
    s_add_u32 m0, s41, 0
    s_add_u32 s57, s52, s45
    buffer_load_dwordx4 v3, s[8:11], s57 offen lds
    s_add_u32 m0, s41, 8192
    s_add_u32 s57, s52, s45
    s_add_u32 s57, s57, 57344
    buffer_load_dwordx4 v3, s[8:11], s57 offen lds
    s_add_u32 m0, s41, 16384
    s_mul_i32 s57, s45, 1344
    buffer_load_dwordx4 v4, s[12:15], s57 offen lds
    s_lshl_b32 s54, s2, 13
    s_add_u32 s54, s54, s41
    s_sub_u32 s55, s54, 1605632
    s_cselect_b32 s54, s54, s55
    s_cselect_b64 s[32:33], s[74:75], s[68:69]
    s_mov_b32 s34, 401408
    s_cselect_b32 s34, 1605632, s34
    s_mov_b32 s35, 0x20000
    buffer_load_dwordx4 v[104:107], v2, s[32:35], s54 offen
    s_mov_b64 s[16:17], s[72:73]
    s_cmp_lt_u32 s43, 5
    s_cselect_b64 s[36:37], s[66:67], s[72:73]
    s_cselect_b32 s38, s14, s18
    s_mov_b32 s39, 0x20000
    s_mov_b32 s54, 1792
    s_cselect_b32 s92, 1344, s54
    s_movk_i32 s54, -640
    s_cselect_b32 s54, 2048, s54
    s_cselect_b64 vcc, -1, 0
    v_cndmask_b32 v6, v5, v4, vcc
    v_add_u32 v6, s54, v6
    v_add_u32 v5, 1408, v5
    s_mov_b64 s[28:29], s[82:83]
    s_mov_b32 s30, 18874368
    s_mov_b32 s31, 0x20000
    s_load_dword s95, s[28:29], 0
    s_cmp_lt_u32 s5, 2
    s_cselect_b32 s55, 1, 2
    s_cselect_b32 s22, 1605632, 0
    s_mov_b32 s26, 401408
    s_cmp_ge_u32 s44, 28
    s_cselect_b32 s91, s55, 0
    s_cselect_b64 s[24:25], s[76:77], s[68:69]
    s_cselect_b32 s26, 896, s26
    s_cselect_b64 s[20:21], s[72:73], s[74:75]
    s_cselect_b32 s22, s22, 1605632
    s_mov_b32 s27, 0x20000
    s_mov_b32 s23, 0x20000
    v_and_b32 v33, 15, v1
    v_lshrrev_b32 v34, 4, v1
    v_and_b32 v35, 6, v1
    v_xor_b32 v35, v35, v34
    v_lshlrev_b32 v35, 4, v35
    v_lshl_add_u32 v35, v33, 7, v35
    s_and_b32 s54, s40, 3
    s_lshl_b32 s54, s54, 12
    v_add_u32 v9, s54, v35
    v_xor_b32 v12, 64, v9
    v_bfe_u32 v33, v1, 2, 2
    v_lshl_add_u32 v35, v34, 3, v33
    v_lshlrev_b32 v35, 7, v35
    v_and_b32 v36, 3, v1
    v_lshl_add_u32 v35, v36, 3, v35
    v_bfe_u32 v36, v1, 3, 2
    s_lshr_b32 s54, s40, 2
    s_lshl_b32 s54, s54, 1
    v_xor_b32 v36, s54, v36
    v_lshl_add_u32 v15, v36, 5, v35
    v_xor_b32 v18, 32, v15
    v_add_u32 v10, 0x10000, v9
    v_add_u32 v11, 0x20000, v9
    v_add_u32 v13, 0x10000, v12
    v_add_u32 v14, 0x20000, v12
    v_add_u32 v16, 0x10000, v15
    v_add_u32 v17, 0x20000, v15
    v_add_u32 v19, 0x10000, v18
    v_add_u32 v20, 0x20000, v18
    s_add_u32 m0, s41, 24576
    s_add_u32 s57, s52, s46
    buffer_load_dwordx4 v3, s[8:11], s57 offen lds
    s_add_u32 m0, s41, 32768
    s_add_u32 s57, s52, s46
    s_add_u32 s57, s57, 57344
    buffer_load_dwordx4 v3, s[8:11], s57 offen lds
    s_add_u32 m0, s41, 40960
    s_mul_i32 s57, s46, 1344
    buffer_load_dwordx4 v4, s[12:15], s57 offen lds
    s_mov_b64 s[32:33], s[78:79]
    s_mov_b32 s34, 1835008
    s_mov_b32 s35, 0x20000
    s_lshr_b32 s54, s44, 4
    s_lshl_b32 s63, s4, 1
    s_add_u32 s63, s63, s54
    s_and_b32 s3, s44, 15
    s_cmp_ge_u32 s44, 28
    s_cselect_b32 s56, 0, -1
    s_mul_i32 s54, s44, 37
    s_lshr_b32 s54, s54, 8
    s_mul_i32 s55, s54, 7
    s_sub_u32 s89, s44, s55
    s_and_b32 s54, s54, 3
    s_lshl_b32 s88, s4, 2
    s_add_u32 s88, s88, s54
    s_add_u32 s55, s54, s89
    s_and_b32 s55, s55, s56
    s_add_u32 s54, s55, s54
    s_lshl_b32 s55, s55, 12
    s_lshl_b32 s54, s54, 12
    s_add_u32 s93, s55, 0
    s_and_b32 s93, s93, 0x3fff
    s_add_u32 s97, s55, 4096
    s_and_b32 s97, s97, 0x3fff
    s_add_u32 s90, s55, 8192
    s_and_b32 s90, s90, 0x3fff
    s_add_u32 s44, s55, 12288
    s_and_b32 s44, s44, 0x3fff
    s_sub_u32 s58, s55, 20480
    s_cselect_b32 s58, s55, s58
    s_add_u32 s59, s58, 4096
    s_cmp_ge_u32 s59, 20480
    s_cselect_b32 s59, 0, s59
    s_add_u32 s60, s59, 4096
    s_cmp_ge_u32 s60, 20480
    s_cselect_b32 s60, 0, s60
    s_add_u32 s61, s60, 4096
    s_cmp_ge_u32 s61, 20480
    s_cselect_b32 s61, 0, s61
    s_add_u32 s62, s61, 4096
    s_cmp_ge_u32 s62, 20480
    s_cselect_b32 s62, 0, s62
    s_add_u32 s80, s54, 0
    s_and_b32 s80, s80, 0x7fff
    s_add_u32 s80, s80, 20480
    s_add_u32 s81, s54, 4096
    s_and_b32 s81, s81, 0x7fff
    s_add_u32 s81, s81, 20480
    s_add_u32 s82, s54, 8192
    s_and_b32 s82, s82, 0x7fff
    s_add_u32 s82, s82, 20480
    s_add_u32 s83, s54, 12288
    s_and_b32 s83, s83, 0x7fff
    s_add_u32 s83, s83, 20480
    s_add_u32 s100, s54, 16384
    s_and_b32 s100, s100, 0x7fff
    s_add_u32 s100, s100, 20480
    s_add_u32 s101, s54, 20480
    s_and_b32 s101, s101, 0x7fff
    s_add_u32 s101, s101, 20480
    s_add_u32 s7, s54, 24576
    s_and_b32 s7, s7, 0x7fff
    s_add_u32 s7, s7, 20480
    s_add_u32 s86, s54, 28672
    s_and_b32 s86, s86, 0x7fff
    s_add_u32 s86, s86, 20480
    s_sub_u32 s54, 16, s43
    s_cmp_eq_u32 s91, 0
    s_cselect_b32 s0, 28, 0x70
    s_cselect_b32 s55, s89, s54
    s_cselect_b32 s54, 57344, 0
    s_cselect_b64 vcc, -1, 0
    s_lshl_b32 s55, s55, 7
    v_cndmask_b32 v7, v5, v3, vcc
    v_add_u32 v7, s55, v7
    v_add_u32 v37, s54, v7
    s_lshl_b32 s54, s45, 4
    s_cmp_eq_u32 s91, 0
    s_cselect_b32 s58, s58, s54
    s_lshl_b32 s54, s47, 4
    s_cmp_eq_u32 s91, 0
    s_cselect_b32 s59, s59, s54
    s_lshl_b32 s54, s49, 4
    s_cmp_eq_u32 s91, 0
    s_cselect_b32 s60, s60, s54
    s_lshl_b32 s54, s51, 4
    s_cmp_eq_u32 s91, 0
    s_cselect_b32 s61, s61, s54
    v_cmp_eq_u32 vcc, 448, v0
    v_mov_b32 v38, 2146435072
    s_lshl_b32 s96, s42, 6
    v_cndmask_b32_e64 v38, v38, 0, vcc
    s_add_u32 s96, s96, s43
    s_lshl_b32 s96, s96, 7
    s_add_u32 s96, s96, 4096
    s_cmp_eq_u32 s40, 0
    s_cselect_b32 s84, -1, 0
    s_cselect_b32 s85, 0, 2146435072
    s_and_b32 s54, s40, 3
    s_lshr_b32 s55, s40, 2
    s_mul_i32 s54, s54, 144
    s_add_u32 s54, s54, s55
    s_mul_i32 s55, s42, 576
    s_add_u32 s54, s54, s55
    s_lshl_b32 s55, s43, 1
    s_add_u32 s54, s54, s55
    s_lshl_b32 s54, s54, 10
    s_add_u32 s54, s54, 8411136
    v_add_u32 v60, s54, v2
    v_add_u32 v61, 73728, v60
    s_lshl_b32 s54, s43, 4
    s_lshr_b32 s55, s40, 2
    s_lshl_b32 s55, s55, 3
    s_add_u32 s54, s54, s55
    v_lshrrev_b32 v41, 4, v1
    v_add_u32 v33, s54, v41
    s_lshl_b32 s54, s42, 2
    s_and_b32 s55, s40, 3
    s_add_u32 s54, s54, s55
    s_lshl_b32 s54, s54, 11
    s_add_u32 s54, s54, 1048576
    v_and_b32 v36, 0xf0, v2
    v_add_u32 v36, s54, v36
    s_cmp_lt_u32 s43, 5
    s_cselect_b64 vcc, -1, 0
    v_mul_u32_u24 v34, 9363, v33
    v_lshrrev_b32 v34, 16, v34
    v_mul_u32_u24 v35, 7, v34
    v_sub_u32 v35, v33, v35
    v_lshl_add_u32 v35, v35, 8, v36
    v_lshl_add_u32 v56, v34, 17, v35
    v_add_u32 v33, 4, v33
    v_mul_u32_u24 v34, 9363, v33
    v_lshrrev_b32 v34, 16, v34
    v_mul_u32_u24 v35, 7, v34
    v_sub_u32 v35, v33, v35
    v_lshl_add_u32 v35, v35, 8, v36
    v_lshl_add_u32 v57, v34, 17, v35
    v_add_u32 v33, 252, v33
    v_mul_u32_u24 v34, 9363, v33
    v_lshrrev_b32 v34, 16, v34
    v_mul_u32_u24 v35, 7, v34
    v_sub_u32 v35, v33, v35
    v_lshl_add_u32 v35, v35, 8, v36
    v_lshl_add_u32 v58, v34, 17, v35
    v_subrev_u32 v35, 32768, v60
    v_cndmask_b32 v58, v35, v58, vcc
    v_add_u32 v33, 4, v33
    v_mul_u32_u24 v34, 9363, v33
    v_lshrrev_b32 v34, 16, v34
    v_mul_u32_u24 v35, 7, v34
    v_sub_u32 v35, v33, v35
    v_lshl_add_u32 v35, v35, 8, v36
    v_lshl_add_u32 v59, v34, 17, v35
    v_subrev_u32 v35, 32768, v61
    v_cndmask_b32 v59, v35, v59, vcc
    v_lshrrev_b32 v40, 1, v1
    v_min_u32 v40, 6, v40
    v_add_u32 v40, 2, v40
    v_mul_u32_u24 v43, 86, v40
    v_lshrrev_b32 v43, 8, v43
    v_mul_u32_u24 v42, 3, v43
    v_sub_u32 v40, v40, v42
    s_sub_u32 s4, s3, 2
    v_add_u32 v40, s4, v40
    v_max_i32 v40, 0, v40
    v_mul_u32_u24 v43, 7, v43
    v_lshl_add_u32 v40, v40, 6, v43
    v_and_b32 v43, 1, v1
    v_mul_u32_u24 v43, 27, v43
    s_mul_i32 s4, s63, 28
    v_add_u32 v43, s4, v43
    v_lshrrev_b32 v43, 6, v43
    v_add_u32 v40, v40, v43
    v_lshlrev_b32 v40, 7, v40
    v_add_u32 v71, 4096, v40
    s_lshl_b32 s54, s63, 17
    s_lshl_b32 s55, s3, 13
    s_add_u32 s54, s54, s55
    s_add_u32 s54, s54, 1048576
    s_lshr_b32 s55, s40, 1
    v_and_b32 v40, 15, v1
    s_and_b32 s56, s40, 1
    s_cselect_b32 s4, 3, 99
    v_cmp_eq_u32 vcc, s4, v41
    s_add_u32 s4, s41, s54
    s_add_u32 s4, s4, 2080768
    v_cndmask_b32_e64 v67, 0, -1, vcc
    v_add_u32 v66, s4, v2
    v_and_b32 v42, 2146435072, v67
    v_or_b32 v66, v66, v42
    s_lshl_b32 s55, s55, 11
    s_lshl_b32 s4, s56, 3
    s_add_u32 s4, s4, s55
    v_add_u32 v54, s4, v2
    v_add_u32 v53, 114688, v54
    v_add_u32 v54, s54, v54
    v_cmp_eq_u32 vcc, 3, v41
    v_mov_b32 v43, 2146435072
    v_lshrrev_b32 v42, 5, v1
    v_cndmask_b32 v55, v54, v43, vcc
    v_lshlrev_b32 v42, 3, v42
    v_xor_b32 v42, v42, v40
    v_lshlrev_b32 v42, 3, v42
    v_lshl_add_u32 v42, v41, 7, v42
    s_lshl_b32 s4, s56, 9
    s_add_u32 s4, s4, s55
    s_add_u32 s4, s4, 139264
    v_add_u32 v64, s4, v42
    s_add_u32 s4, s41, 114688
    v_add_u32 v65, s4, v2
    v_lshlrev_b32 v42, 2, v41
    v_mov_b32 v43, 0xff000000
    v_cmp_gt_u32 vcc, v42, v40
    v_add_u32 v42, 1, v42
    s_nop 0
    v_cndmask_b32_e64 v240, v43, 0, vcc
    v_cndmask_b32_e64 v244, 0, v43, vcc
    v_cmp_gt_u32 vcc, v42, v40
    v_add_u32 v42, 1, v42
    s_nop 0
    v_cndmask_b32_e64 v241, v43, 0, vcc
    v_cndmask_b32_e64 v245, 0, v43, vcc
    v_cmp_gt_u32 vcc, v42, v40
    v_add_u32 v42, 1, v42
    s_nop 0
    v_cndmask_b32_e64 v242, v43, 0, vcc
    v_cndmask_b32_e64 v246, 0, v43, vcc
    v_cmp_gt_u32 vcc, v42, v40
    v_add_u32 v42, 1, v42
    s_nop 0
    v_cndmask_b32_e64 v243, v43, 0, vcc
    v_cndmask_b32_e64 v247, 0, v43, vcc
    v_mov_b32 v8, 0x3e8b97f6
    v_and_b32 v42, 3, v1
    v_lshrrev_b32 v43, 2, v1
    v_and_b32 v40, 2, v1
    v_lshlrev_b32 v40, 2, v40
    v_xor_b32 v40, v43, v40
    v_lshlrev_b32 v40, 3, v40
    v_lshl_add_u32 v40, v42, 7, v40
    s_add_u32 s4, s41, 139264
    v_add_u32 v68, s4, v40
    v_lshlrev_b32 v43, 7, v43
    v_lshl_add_u32 v43, v42, 3, v43
    v_bfe_u32 v42, v1, 3, 2
    s_lshr_b32 s55, s40, 1
    s_and_b32 s4, s55, 2
    v_xor_b32 v42, s4, v42
    v_lshl_add_u32 v43, v42, 5, v43
    s_lshl_b32 s4, s55, 12
    v_add_u32 v21, s4, v43
    v_xor_b32 v24, 32, v21
    v_xor_b32 v27, 64, v21
    v_xor_b32 v30, 96, v21
    v_add_u32 v22, 0x10000, v21
    v_add_u32 v23, 0x20000, v21
    v_add_u32 v25, 0x10000, v24
    v_add_u32 v26, 0x20000, v24
    v_add_u32 v28, 0x10000, v27
    v_add_u32 v29, 0x20000, v27
    v_add_u32 v31, 0x10000, v30
    v_add_u32 v32, 0x20000, v30
    s_lshl_b32 s56, s56, 1
    s_and_b32 s4, s55, 1
    s_add_u32 s56, s56, s4
    s_lshl_b32 s6, s88, 2
    s_add_u32 s6, s6, s56
    s_xor_b32 s4, s6, 1
    s_mul_i32 s4, s4, 72
    s_add_u32 s4, s4, s55
    s_lshl_b32 s4, s4, 10
    s_add_u32 s4, s4, 8388608
    v_add_u32 v70, s4, v2
    s_xor_b32 s4, s6, 0
    s_mul_i32 s4, s4, 72
    s_add_u32 s4, s4, s55
    s_lshl_b32 s4, s4, 10
    s_add_u32 s4, s4, 8388608
    v_add_u32 v0, s4, v2
    s_lshr_b32 s54, s88, 1
    s_lshl_b32 s4, s54, 13
    s_add_u32 s4, s4, 6784
    v_min_u32 v40, 28, v1
    v_lshl_add_u32 v69, v40, 7, s4
    s_lshl_b32 s54, s54, 11
    s_add_u32 s88, s54, 135168
    s_lshr_b32 s55, s40, 2
    s_mul_i32 s87, s55, 3584
    s_lshl_b32 s55, s55, 6
    s_lshl_b32 s89, s89, 7
    s_add_u32 s89, s89, s55
    s_mul_i32 s55, s6, 14336
    s_add_u32 s89, s89, s55
    s_lshl_b32 s54, s3, 3
    s_add_u32 s54, s54, s40
    s_mul_i32 s54, s54, 72
    s_add_u32 s54, s54, s63
    s_lshl_b32 s54, s54, 10
    s_add_u32 s1, s54, 8445952
    s_lshl_b32 s54, s3, 4
    s_add_u32 s54, s54, s63
    s_lshl_b32 s54, s54, 7
    s_add_u32 s5, s54, 135168
    s_mov_b32 s54, 2139095040
    s_cmp_ge_u32 s3, 1
    s_cselect_b32 s63, 8192, s54
    s_cmp_ge_u32 s3, 2
    s_cselect_b32 s3, 0, s54
    s_lshl_b32 s94, s46, 4
    s_lshl_b32 s4, s48, 4
    s_lshl_b32 s54, s50, 4
    s_cmp_eq_u32 s91, 0
    s_cselect_b32 s94, s58, s94
    s_cselect_b32 s4, s59, s4
    s_cselect_b32 s54, s60, s54
    s_add_u32 m0, s41, 49152
    s_mul_i32 s57, s45, s92
    buffer_load_dwordx4 v6, s[36:39], s57 offen lds
    s_add_u32 m0, s41, 114688
    s_mul_i32 s57, s45, 1792
    buffer_load_dwordx4 v5, s[16:19], s57 offen lds
    s_add_u32 m0, s41, 57344
    s_add_u32 s57, s52, s47
    buffer_load_dwordx4 v3, s[8:11], s57 offen lds
    s_add_u32 m0, s41, 65536
    s_add_u32 s57, s52, s47
    s_add_u32 s57, s57, 57344
    buffer_load_dwordx4 v3, s[8:11], s57 offen lds
    s_add_u32 m0, s41, 73728
    s_mul_i32 s57, s47, 1344
    buffer_load_dwordx4 v4, s[12:15], s57 offen lds
    s_waitcnt lgkmcnt(0)
    s_mul_i32 s53, s95, 0x9E3779B1
    s_add_u32 s53, s53, 0x7F4A7C15
    v_mov_b32 v39, s53
    s_waitcnt vmcnt(9)
    s_barrier
    ds_read_b128 v[128:131], v9 offset:0
    ds_read_b128 v[184:187], v9 offset:2048
    ds_read_b64_tr_b16 v[72:73], v15 offset:16384
    ds_read_b64_tr_b16 v[74:75], v15 offset:16896
    ds_read_b64_tr_b16 v[76:77], v18 offset:16384
    ds_read_b64_tr_b16 v[78:79], v18 offset:16896
    ds_read_b128 v[132:135], v12 offset:0
    ds_read_b128 v[188:191], v12 offset:2048
    ds_read_b64_tr_b16 v[80:81], v15 offset:20480
    ds_read_b64_tr_b16 v[82:83], v15 offset:20992
    ds_read_b64_tr_b16 v[84:85], v18 offset:20480
    ds_read_b64_tr_b16 v[86:87], v18 offset:20992
    s_waitcnt lgkmcnt(0)
    s_waitcnt vmcnt(5)
    s_barrier
    v_mfma_f32_16x16x32_bf16 v[112:115], v[72:75], v[128:131], 0
    ds_read_b128 v[136:139], v9 offset:24576
    ds_read_b128 v[192:195], v9 offset:26624
    s_add_u32 m0, s41, 81920
    s_add_u32 s57, s52, s48
    v_mfma_f32_16x16x32_bf16 v[116:119], v[76:79], v[128:131], 0
    buffer_load_dwordx4 v3, s[8:11], s57 offen lds
    ds_read_b64_tr_b16 v[88:89], v15 offset:40960
    ds_read_b64_tr_b16 v[90:91], v15 offset:41472
    v_mfma_f32_16x16x32_bf16 v[120:123], v[72:75], v[184:187], 0
    ds_read_b64_tr_b16 v[92:93], v18 offset:40960
    ds_read_b64_tr_b16 v[94:95], v18 offset:41472
    v_mfma_f32_16x16x32_bf16 v[124:127], v[76:79], v[184:187], 0
    ds_read_b128 v[140:143], v12 offset:24576
    ds_read_b128 v[196:199], v12 offset:26624
    s_add_u32 m0, s41, 90112
    s_add_u32 s57, s52, s48
    s_add_u32 s57, s57, 57344
    v_mfma_f32_16x16x32_bf16 v[112:115], v[80:83], v[132:135], v[112:115]
    buffer_load_dwordx4 v3, s[8:11], s57 offen lds
    ds_read_b64_tr_b16 v[96:97], v15 offset:45056
    ds_read_b64_tr_b16 v[98:99], v15 offset:45568
    v_mfma_f32_16x16x32_bf16 v[116:119], v[84:87], v[132:135], v[116:119]
    ds_read_b64_tr_b16 v[100:101], v18 offset:45056
    ds_read_b64_tr_b16 v[102:103], v18 offset:45568
    s_add_u32 m0, s41, 98304
    s_mul_i32 s57, s48, 1344
    v_mfma_f32_16x16x32_bf16 v[120:123], v[80:83], v[188:191], v[120:123]
    buffer_load_dwordx4 v4, s[12:15], s57 offen lds
    v_mfma_f32_16x16x32_bf16 v[124:127], v[84:87], v[188:191], v[124:127]
    s_waitcnt lgkmcnt(0)
    s_waitcnt vmcnt(3)
    s_barrier
    v_mfma_f32_16x16x32_bf16 v[112:115], v[88:91], v[136:139], v[112:115]
    ds_read_b128 v[144:147], v9 offset:57344
    ds_read_b128 v[200:203], v9 offset:59392
    s_add_u32 m0, s41, 122880
    s_add_u32 s57, s52, s49
    v_mfma_f32_16x16x32_bf16 v[116:119], v[92:95], v[136:139], v[116:119]
    buffer_load_dwordx4 v3, s[8:11], s57 offen lds
    ds_read_b64_tr_b16 v[72:73], v16 offset:8192
    ds_read_b64_tr_b16 v[74:75], v16 offset:8704
    v_mfma_f32_16x16x32_bf16 v[120:123], v[88:91], v[192:195], v[120:123]
    ds_read_b64_tr_b16 v[76:77], v19 offset:8192
    ds_read_b64_tr_b16 v[78:79], v19 offset:8704
    v_mfma_f32_16x16x32_bf16 v[124:127], v[92:95], v[192:195], v[124:127]
    ds_read_b128 v[148:151], v12 offset:57344
    ds_read_b128 v[204:207], v12 offset:59392
    s_add_u32 m0, s41, 131072
    s_add_u32 s57, s52, s49
    s_add_u32 s57, s57, 57344
    v_mfma_f32_16x16x32_bf16 v[112:115], v[96:99], v[140:143], v[112:115]
    buffer_load_dwordx4 v3, s[8:11], s57 offen lds
    ds_read_b64_tr_b16 v[80:81], v16 offset:12288
    ds_read_b64_tr_b16 v[82:83], v16 offset:12800
    v_mfma_f32_16x16x32_bf16 v[116:119], v[100:103], v[140:143], v[116:119]
    ds_read_b64_tr_b16 v[84:85], v19 offset:12288
    ds_read_b64_tr_b16 v[86:87], v19 offset:12800
    s_add_u32 m0, s41, 106496
    s_mul_i32 s57, s49, 1344
    v_mfma_f32_16x16x32_bf16 v[120:123], v[96:99], v[196:199], v[120:123]
    buffer_load_dwordx4 v4, s[12:15], s57 offen lds
    v_mfma_f32_16x16x32_bf16 v[124:127], v[100:103], v[196:199], v[124:127]
    s_waitcnt lgkmcnt(0)
    s_waitcnt vmcnt(3)
    s_barrier
    v_mfma_f32_16x16x32_bf16 v[112:115], v[72:75], v[144:147], v[112:115]
    ds_read_b128 v[152:155], v10 offset:16384
    ds_read_b128 v[208:211], v10 offset:18432
    s_add_u32 m0, s41, 139264
    s_add_u32 s57, s52, s50
    v_mfma_f32_16x16x32_bf16 v[116:119], v[76:79], v[144:147], v[116:119]
    buffer_load_dwordx4 v3, s[8:11], s57 offen lds
    ds_read_b64_tr_b16 v[88:89], v16 offset:32768
    ds_read_b64_tr_b16 v[90:91], v16 offset:33280
    v_mfma_f32_16x16x32_bf16 v[120:123], v[72:75], v[200:203], v[120:123]
    ds_read_b64_tr_b16 v[92:93], v19 offset:32768
    ds_read_b64_tr_b16 v[94:95], v19 offset:33280
    v_mfma_f32_16x16x32_bf16 v[124:127], v[76:79], v[200:203], v[124:127]
    ds_read_b128 v[156:159], v13 offset:16384
    ds_read_b128 v[212:215], v13 offset:18432
    s_add_u32 m0, s41, 147456
    s_add_u32 s57, s52, s50
    s_add_u32 s57, s57, 57344
    v_mfma_f32_16x16x32_bf16 v[112:115], v[80:83], v[148:151], v[112:115]
    buffer_load_dwordx4 v3, s[8:11], s57 offen lds
    ds_read_b64_tr_b16 v[96:97], v16 offset:36864
    ds_read_b64_tr_b16 v[98:99], v16 offset:37376
    v_mfma_f32_16x16x32_bf16 v[116:119], v[84:87], v[148:151], v[116:119]
    ds_read_b64_tr_b16 v[100:101], v19 offset:36864
    ds_read_b64_tr_b16 v[102:103], v19 offset:37376
    s_add_u32 m0, s41, 155648
    s_mul_i32 s57, s50, 1344
    v_mfma_f32_16x16x32_bf16 v[120:123], v[80:83], v[204:207], v[120:123]
    buffer_load_dwordx4 v4, s[12:15], s57 offen lds
    v_mfma_f32_16x16x32_bf16 v[124:127], v[84:87], v[204:207], v[124:127]
    s_waitcnt lgkmcnt(0)
    s_waitcnt vmcnt(3)
    s_barrier
    v_mfma_f32_16x16x32_bf16 v[112:115], v[88:91], v[152:155], v[112:115]
    ds_read_b128 v[160:163], v10 offset:57344
    ds_read_b128 v[216:219], v10 offset:59392
    s_add_u32 m0, s41, 0
    s_add_u32 s57, s52, s51
    v_mfma_f32_16x16x32_bf16 v[116:119], v[92:95], v[152:155], v[116:119]
    buffer_load_dwordx4 v3, s[8:11], s57 offen lds
    ds_read_b64_tr_b16 v[72:73], v16 offset:40960
    ds_read_b64_tr_b16 v[74:75], v16 offset:41472
    v_mfma_f32_16x16x32_bf16 v[120:123], v[88:91], v[208:211], v[120:123]
    ds_read_b64_tr_b16 v[76:77], v19 offset:40960
    ds_read_b64_tr_b16 v[78:79], v19 offset:41472
    v_mfma_f32_16x16x32_bf16 v[124:127], v[92:95], v[208:211], v[124:127]
    ds_read_b128 v[164:167], v13 offset:57344
    ds_read_b128 v[220:223], v13 offset:59392
    s_add_u32 m0, s41, 8192
    s_add_u32 s57, s52, s51
    s_add_u32 s57, s57, 57344
    v_mfma_f32_16x16x32_bf16 v[112:115], v[96:99], v[156:159], v[112:115]
    buffer_load_dwordx4 v3, s[8:11], s57 offen lds
    ds_read_b64_tr_b16 v[80:81], v16 offset:45056
    ds_read_b64_tr_b16 v[82:83], v16 offset:45568
    v_mfma_f32_16x16x32_bf16 v[116:119], v[100:103], v[156:159], v[116:119]
    ds_read_b64_tr_b16 v[84:85], v19 offset:45056
    ds_read_b64_tr_b16 v[86:87], v19 offset:45568
    s_add_u32 m0, s41, 16384
    s_mul_i32 s57, s51, 1344
    v_mfma_f32_16x16x32_bf16 v[120:123], v[96:99], v[212:215], v[120:123]
    buffer_load_dwordx4 v4, s[12:15], s57 offen lds
    v_mfma_f32_16x16x32_bf16 v[124:127], v[100:103], v[212:215], v[124:127]
    s_waitcnt lgkmcnt(0)
    s_waitcnt vmcnt(3)
    s_barrier
    v_mfma_f32_16x16x32_bf16 v[112:115], v[72:75], v[160:163], v[112:115]
    ds_read_b128 v[168:171], v11 offset:8192
    ds_read_b128 v[224:227], v11 offset:10240
    v_mfma_f32_16x16x32_bf16 v[116:119], v[76:79], v[160:163], v[116:119]
    ds_read_b64_tr_b16 v[88:89], v17 offset:24576
    ds_read_b64_tr_b16 v[90:91], v17 offset:25088
    v_mfma_f32_16x16x32_bf16 v[120:123], v[72:75], v[216:219], v[120:123]
    ds_read_b64_tr_b16 v[92:93], v20 offset:24576
    ds_read_b64_tr_b16 v[94:95], v20 offset:25088
    v_mfma_f32_16x16x32_bf16 v[124:127], v[76:79], v[216:219], v[124:127]
    ds_read_b128 v[172:175], v14 offset:8192
    ds_read_b128 v[228:231], v14 offset:10240
    s_add_u32 m0, s41, 57344
    s_mul_i32 s57, s46, s92
    v_mfma_f32_16x16x32_bf16 v[112:115], v[80:83], v[164:167], v[112:115]
    buffer_load_dwordx4 v6, s[36:39], s57 offen lds
    ds_read_b64_tr_b16 v[96:97], v17 offset:28672
    ds_read_b64_tr_b16 v[98:99], v17 offset:29184
    v_mfma_f32_16x16x32_bf16 v[116:119], v[84:87], v[164:167], v[116:119]
    ds_read_b64_tr_b16 v[100:101], v20 offset:28672
    ds_read_b64_tr_b16 v[102:103], v20 offset:29184
    s_add_u32 m0, s41, 65536
    s_mul_i32 s57, s47, s92
    v_mfma_f32_16x16x32_bf16 v[120:123], v[80:83], v[220:223], v[120:123]
    buffer_load_dwordx4 v6, s[36:39], s57 offen lds
    v_mfma_f32_16x16x32_bf16 v[124:127], v[84:87], v[220:223], v[124:127]
    s_waitcnt lgkmcnt(0)
    s_waitcnt vmcnt(2)
    s_barrier
    v_mfma_f32_16x16x32_bf16 v[112:115], v[88:91], v[168:171], v[112:115]
    ds_read_b128 v[176:179], v9 offset:0
    ds_read_b128 v[232:235], v9 offset:2048
    v_mfma_f32_16x16x32_bf16 v[116:119], v[92:95], v[168:171], v[116:119]
    ds_read_b64_tr_b16 v[72:73], v15 offset:16384
    ds_read_b64_tr_b16 v[74:75], v15 offset:16896
    v_mfma_f32_16x16x32_bf16 v[120:123], v[88:91], v[224:227], v[120:123]
    ds_read_b64_tr_b16 v[76:77], v18 offset:16384
    ds_read_b64_tr_b16 v[78:79], v18 offset:16896
    v_mfma_f32_16x16x32_bf16 v[124:127], v[92:95], v[224:227], v[124:127]
    ds_read_b128 v[180:183], v12 offset:0
    ds_read_b128 v[236:239], v12 offset:2048
    s_add_u32 m0, s41, 73728
    s_mul_i32 s57, s48, s92
    v_mfma_f32_16x16x32_bf16 v[112:115], v[96:99], v[172:175], v[112:115]
    buffer_load_dwordx4 v6, s[36:39], s57 offen lds
    ds_read_b64_tr_b16 v[80:81], v15 offset:20480
    ds_read_b64_tr_b16 v[82:83], v15 offset:20992
    v_mfma_f32_16x16x32_bf16 v[116:119], v[100:103], v[172:175], v[116:119]
    ds_read_b64_tr_b16 v[84:85], v18 offset:20480
    ds_read_b64_tr_b16 v[86:87], v18 offset:20992
    s_add_u32 m0, s41, 81920
    s_mul_i32 s57, s49, s92
    v_mfma_f32_16x16x32_bf16 v[120:123], v[96:99], v[228:231], v[120:123]
    buffer_load_dwordx4 v6, s[36:39], s57 offen lds
    v_mfma_f32_16x16x32_bf16 v[124:127], v[100:103], v[228:231], v[124:127]
    s_waitcnt lgkmcnt(0)
    s_barrier
    v_mfma_f32_16x16x32_bf16 v[112:115], v[72:75], v[176:179], v[112:115]
    ds_read_b64_tr_b16 v[88:89], v15 offset:49152
    ds_read_b64_tr_b16 v[90:91], v15 offset:49664
    v_mov_b32 v3, v64
    v_mfma_f32_16x16x32_bf16 v[116:119], v[76:79], v[176:179], v[116:119]
    ds_read_b64_tr_b16 v[92:93], v18 offset:49152
    ds_read_b64_tr_b16 v[94:95], v18 offset:49664
    v_mov_b32 v4, v65
    v_mfma_f32_16x16x32_bf16 v[120:123], v[72:75], v[232:235], v[120:123]
    ds_read_b64_tr_b16 v[96:97], v15 offset:53248
    ds_read_b64_tr_b16 v[98:99], v15 offset:53760
    v_mov_b32 v9, v66
    v_mfma_f32_16x16x32_bf16 v[124:127], v[76:79], v[232:235], v[124:127]
    ds_read_b64_tr_b16 v[100:101], v18 offset:53248
    ds_read_b64_tr_b16 v[102:103], v18 offset:53760
    s_add_u32 m0, s41, 90112
    s_mul_i32 s57, s50, s92
    v_mov_b32 v10, v67
    v_mfma_f32_16x16x32_bf16 v[112:115], v[80:83], v[180:183], v[112:115]
    buffer_load_dwordx4 v6, s[36:39], s57 offen lds
    v_mov_b32 v11, v68
    v_mfma_f32_16x16x32_bf16 v[116:119], v[84:87], v[180:183], v[116:119]
    s_add_u32 m0, s41, 98304
    s_mul_i32 s57, s51, s92
    v_mov_b32 v12, v69
    v_mfma_f32_16x16x32_bf16 v[120:123], v[80:83], v[236:239], v[120:123]
    buffer_load_dwordx4 v6, s[36:39], s57 offen lds
    v_mov_b32 v13, v70
    v_mfma_f32_16x16x32_bf16 v[124:127], v[84:87], v[236:239], v[124:127]
    v_mov_b32 v14, v71
    v_cvt_pk_bf16_f32 v104, v112, v113
    v_cvt_pk_bf16_f32 v105, v114, v115
    v_cvt_pk_bf16_f32 v108, v116, v117
    v_cvt_pk_bf16_f32 v109, v118, v119
    v_cvt_pk_bf16_f32 v106, v120, v121
    v_cvt_pk_bf16_f32 v107, v122, v123
    buffer_store_dwordx4 v[104:107], v56, s[28:31], 0 offen sc1
    v_cvt_pk_bf16_f32 v110, v124, v125
    v_cvt_pk_bf16_f32 v111, v126, v127
    buffer_store_dwordx4 v[108:111], v57, s[28:31], 0 offen sc1
    s_waitcnt lgkmcnt(0)
    s_waitcnt vmcnt(6)
    s_barrier
    v_mfma_f32_16x16x32_bf16 v[112:115], v[88:91], v[128:131], 0
    ds_read_b64_tr_b16 v[72:73], v15 offset:57344
    ds_read_b64_tr_b16 v[74:75], v15 offset:57856
    v_mfma_f32_16x16x32_bf16 v[116:119], v[92:95], v[128:131], 0
    ds_read_b64_tr_b16 v[76:77], v18 offset:57344
    ds_read_b64_tr_b16 v[78:79], v18 offset:57856
    v_mfma_f32_16x16x32_bf16 v[120:123], v[88:91], v[184:187], 0
    ds_read_b64_tr_b16 v[80:81], v15 offset:61440
    ds_read_b64_tr_b16 v[82:83], v15 offset:61952
    v_mfma_f32_16x16x32_bf16 v[124:127], v[92:95], v[184:187], 0
    ds_read_b64_tr_b16 v[84:85], v18 offset:61440
    ds_read_b64_tr_b16 v[86:87], v18 offset:61952
    s_add_u32 m0, s41, 32768
    s_mul_i32 s52, s58, s0
    v_mfma_f32_16x16x32_bf16 v[112:115], v[96:99], v[132:135], v[112:115]
    buffer_load_dwordx4 v7, s[20:23], s52 offen lds
    v_mfma_f32_16x16x32_bf16 v[116:119], v[100:103], v[132:135], v[116:119]
    s_add_u32 m0, s41, 40960
    s_mul_i32 s52, s94, s0
    v_mfma_f32_16x16x32_bf16 v[120:123], v[96:99], v[188:191], v[120:123]
    buffer_load_dwordx4 v37, s[20:23], s52 offen lds
    v_mfma_f32_16x16x32_bf16 v[124:127], v[100:103], v[188:191], v[124:127]
    s_waitcnt lgkmcnt(0)
    v_mfma_f32_16x16x32_bf16 v[112:115], v[72:75], v[136:139], v[112:115]
    ds_read_b64_tr_b16 v[88:89], v16 offset:0
    ds_read_b64_tr_b16 v[90:91], v16 offset:512
    v_mfma_f32_16x16x32_bf16 v[116:119], v[76:79], v[136:139], v[116:119]
    ds_read_b64_tr_b16 v[92:93], v19 offset:0
    ds_read_b64_tr_b16 v[94:95], v19 offset:512
    v_mfma_f32_16x16x32_bf16 v[120:123], v[72:75], v[192:195], v[120:123]
    ds_read_b64_tr_b16 v[96:97], v16 offset:4096
    ds_read_b64_tr_b16 v[98:99], v16 offset:4608
    v_mfma_f32_16x16x32_bf16 v[124:127], v[76:79], v[192:195], v[124:127]
    ds_read_b64_tr_b16 v[100:101], v19 offset:4096
    ds_read_b64_tr_b16 v[102:103], v19 offset:4608
    v_mfma_f32_16x16x32_bf16 v[112:115], v[80:83], v[140:143], v[112:115]
    s_add_u32 m0, s41, 122880
    s_mul_i32 s57, s46, 1792
    v_mfma_f32_16x16x32_bf16 v[116:119], v[84:87], v[140:143], v[116:119]
    buffer_load_dwordx4 v5, s[16:19], s57 offen lds
    v_mfma_f32_16x16x32_bf16 v[120:123], v[80:83], v[196:199], v[120:123]
    v_mfma_f32_16x16x32_bf16 v[124:127], v[84:87], v[196:199], v[124:127]
    s_waitcnt lgkmcnt(0)
    s_waitcnt vmcnt(7)
    s_barrier
    v_mfma_f32_16x16x32_bf16 v[112:115], v[88:91], v[144:147], v[112:115]
    ds_read_b64_tr_b16 v[72:73], v16 offset:8192
    ds_read_b64_tr_b16 v[74:75], v16 offset:8704
    v_mfma_f32_16x16x32_bf16 v[116:119], v[92:95], v[144:147], v[116:119]
    ds_read_b64_tr_b16 v[76:77], v19 offset:8192
    ds_read_b64_tr_b16 v[78:79], v19 offset:8704
    v_mfma_f32_16x16x32_bf16 v[120:123], v[88:91], v[200:203], v[120:123]
    ds_read_b64_tr_b16 v[80:81], v16 offset:12288
    ds_read_b64_tr_b16 v[82:83], v16 offset:12800
    v_mfma_f32_16x16x32_bf16 v[124:127], v[92:95], v[200:203], v[124:127]
    ds_read_b64_tr_b16 v[84:85], v19 offset:12288
    ds_read_b64_tr_b16 v[86:87], v19 offset:12800
    v_mfma_f32_16x16x32_bf16 v[112:115], v[96:99], v[148:151], v[112:115]
    s_add_u32 m0, s41, 131072
    s_mul_i32 s57, s47, 1792
    v_mfma_f32_16x16x32_bf16 v[116:119], v[100:103], v[148:151], v[116:119]
    buffer_load_dwordx4 v5, s[16:19], s57 offen lds
    v_mfma_f32_16x16x32_bf16 v[120:123], v[96:99], v[204:207], v[120:123]
    v_mfma_f32_16x16x32_bf16 v[124:127], v[100:103], v[204:207], v[124:127]
    s_waitcnt lgkmcnt(0)
    v_mfma_f32_16x16x32_bf16 v[112:115], v[72:75], v[152:155], v[112:115]
    ds_read_b64_tr_b16 v[88:89], v16 offset:16384
    ds_read_b64_tr_b16 v[90:91], v16 offset:16896
    v_mfma_f32_16x16x32_bf16 v[116:119], v[76:79], v[152:155], v[116:119]
    ds_read_b64_tr_b16 v[92:93], v19 offset:16384
    ds_read_b64_tr_b16 v[94:95], v19 offset:16896
    v_mfma_f32_16x16x32_bf16 v[120:123], v[72:75], v[208:211], v[120:123]
    ds_read_b64_tr_b16 v[96:97], v16 offset:20480
    ds_read_b64_tr_b16 v[98:99], v16 offset:20992
    v_mfma_f32_16x16x32_bf16 v[124:127], v[76:79], v[208:211], v[124:127]
    ds_read_b64_tr_b16 v[100:101], v19 offset:20480
    ds_read_b64_tr_b16 v[102:103], v19 offset:20992
    s_add_u32 m0, s41, 16384
    s_mul_i32 s52, s80, s0
    v_mfma_f32_16x16x32_bf16 v[112:115], v[80:83], v[156:159], v[112:115]
    buffer_load_dwordx4 v7, s[20:23], s52 offen lds
    v_mfma_f32_16x16x32_bf16 v[116:119], v[84:87], v[156:159], v[116:119]
    s_add_u32 m0, s41, 24576
    v_mfma_f32_16x16x32_bf16 v[120:123], v[80:83], v[212:215], v[120:123]
    buffer_load_dwordx4 v37, s[20:23], s52 offen lds
    v_mfma_f32_16x16x32_bf16 v[124:127], v[84:87], v[212:215], v[124:127]
    s_waitcnt lgkmcnt(0)
    s_waitcnt vmcnt(6)
    s_barrier
    buffer_store_dword v39, v38, s[28:31], s96 offen offset:0 sc1
    v_mfma_f32_16x16x32_bf16 v[112:115], v[88:91], v[160:163], v[112:115]
    ds_read_b64_tr_b16 v[72:73], v16 offset:24576
    ds_read_b64_tr_b16 v[74:75], v16 offset:25088
    v_mfma_f32_16x16x32_bf16 v[116:119], v[92:95], v[160:163], v[116:119]
    ds_read_b64_tr_b16 v[76:77], v19 offset:24576
    ds_read_b64_tr_b16 v[78:79], v19 offset:25088
    v_mfma_f32_16x16x32_bf16 v[120:123], v[88:91], v[216:219], v[120:123]
    ds_read_b64_tr_b16 v[80:81], v16 offset:28672
    ds_read_b64_tr_b16 v[82:83], v16 offset:29184
    v_mfma_f32_16x16x32_bf16 v[124:127], v[92:95], v[216:219], v[124:127]
    ds_read_b64_tr_b16 v[84:85], v19 offset:28672
    ds_read_b64_tr_b16 v[86:87], v19 offset:29184
    v_mfma_f32_16x16x32_bf16 v[112:115], v[96:99], v[164:167], v[112:115]
    s_add_u32 m0, s41, 139264
    s_mul_i32 s57, s48, 1792
    v_mfma_f32_16x16x32_bf16 v[116:119], v[100:103], v[164:167], v[116:119]
    buffer_load_dwordx4 v5, s[16:19], s57 offen lds
    v_mfma_f32_16x16x32_bf16 v[120:123], v[96:99], v[220:223], v[120:123]
    v_mfma_f32_16x16x32_bf16 v[124:127], v[100:103], v[220:223], v[124:127]
    s_waitcnt lgkmcnt(0)
    v_mfma_f32_16x16x32_bf16 v[112:115], v[72:75], v[168:171], v[112:115]
    ds_read_b64_tr_b16 v[88:89], v16 offset:32768
    ds_read_b64_tr_b16 v[90:91], v16 offset:33280
    v_mfma_f32_16x16x32_bf16 v[116:119], v[76:79], v[168:171], v[116:119]
    ds_read_b64_tr_b16 v[92:93], v19 offset:32768
    ds_read_b64_tr_b16 v[94:95], v19 offset:33280
    v_mfma_f32_16x16x32_bf16 v[120:123], v[72:75], v[224:227], v[120:123]
    ds_read_b64_tr_b16 v[96:97], v16 offset:36864
    ds_read_b64_tr_b16 v[98:99], v16 offset:37376
    v_mfma_f32_16x16x32_bf16 v[124:127], v[76:79], v[224:227], v[124:127]
    ds_read_b64_tr_b16 v[100:101], v19 offset:36864
    ds_read_b64_tr_b16 v[102:103], v19 offset:37376
    s_add_u32 m0, s41, 147456
    s_mul_i32 s57, s49, 1792
    v_mfma_f32_16x16x32_bf16 v[112:115], v[80:83], v[172:175], v[112:115]
    buffer_load_dwordx4 v5, s[16:19], s57 offen lds
    v_mfma_f32_16x16x32_bf16 v[116:119], v[84:87], v[172:175], v[116:119]
    s_add_u32 m0, s41, 155648
    s_mul_i32 s57, s50, 1792
    v_mfma_f32_16x16x32_bf16 v[120:123], v[80:83], v[228:231], v[120:123]
    buffer_load_dwordx4 v5, s[16:19], s57 offen lds
    v_mfma_f32_16x16x32_bf16 v[124:127], v[84:87], v[228:231], v[124:127]
    s_waitcnt lgkmcnt(0)
    s_waitcnt vmcnt(7)
    s_barrier
    v_mfma_f32_16x16x32_bf16 v[112:115], v[88:91], v[176:179], v[112:115]
    ds_read_b64_tr_b16 v[72:73], v16 offset:49152
    ds_read_b64_tr_b16 v[74:75], v16 offset:49664
    v_mfma_f32_16x16x32_bf16 v[116:119], v[92:95], v[176:179], v[116:119]
    ds_read_b64_tr_b16 v[76:77], v19 offset:49152
    ds_read_b64_tr_b16 v[78:79], v19 offset:49664
    v_mfma_f32_16x16x32_bf16 v[120:123], v[88:91], v[232:235], v[120:123]
    ds_read_b64_tr_b16 v[80:81], v16 offset:53248
    ds_read_b64_tr_b16 v[82:83], v16 offset:53760
    v_mfma_f32_16x16x32_bf16 v[124:127], v[92:95], v[232:235], v[124:127]
    ds_read_b64_tr_b16 v[84:85], v19 offset:53248
    ds_read_b64_tr_b16 v[86:87], v19 offset:53760
    v_mfma_f32_16x16x32_bf16 v[112:115], v[96:99], v[180:183], v[112:115]
    s_add_u32 m0, s41, 106496
    s_mul_i32 s57, s51, 1792
    v_mfma_f32_16x16x32_bf16 v[116:119], v[100:103], v[180:183], v[116:119]
    buffer_load_dwordx4 v5, s[16:19], s57 offen lds
    v_mfma_f32_16x16x32_bf16 v[120:123], v[96:99], v[236:239], v[120:123]
    v_mfma_f32_16x16x32_bf16 v[124:127], v[100:103], v[236:239], v[124:127]
    s_cmp_lt_u32 s43, 5
    s_cbranch_scc1 L_epi1q
    v_cvt_pk_bf16_f32 v104, v112, v113
    v_cvt_pk_bf16_f32 v105, v114, v115
    v_pk_max_i16 v104, v104, 0
    v_pk_max_i16 v105, v105, 0
    v_cvt_pk_bf16_f32 v106, v116, v117
    v_cvt_pk_bf16_f32 v107, v118, v119
    v_pk_max_i16 v106, v106, 0
    v_pk_max_i16 v107, v107, 0
    buffer_store_dwordx4 v[104:107], v58, s[28:31], 0 offen sc1
    v_cvt_pk_bf16_f32 v108, v120, v121
    v_cvt_pk_bf16_f32 v109, v122, v123
    v_pk_max_i16 v108, v108, 0
    v_pk_max_i16 v109, v109, 0
    v_cvt_pk_bf16_f32 v110, v124, v125
    v_cvt_pk_bf16_f32 v111, v126, v127
    v_pk_max_i16 v110, v110, 0
    v_pk_max_i16 v111, v111, 0
    buffer_store_dwordx4 v[108:111], v59, s[28:31], 0 offen sc1
    s_branch L_epi1d
L_epi1q:
    v_cvt_pk_bf16_f32 v104, v112, v113
    v_cvt_pk_bf16_f32 v105, v114, v115
    s_nop 0
    v_cvt_pk_bf16_f32 v108, v116, v117
    v_cvt_pk_bf16_f32 v109, v118, v119
    v_cvt_pk_bf16_f32 v106, v120, v121
    v_cvt_pk_bf16_f32 v107, v122, v123
    buffer_store_dwordx4 v[104:107], v58, s[28:31], 0 offen sc1
    v_cvt_pk_bf16_f32 v110, v124, v125
    v_cvt_pk_bf16_f32 v111, v126, v127
    buffer_store_dwordx4 v[108:111], v59, s[28:31], 0 offen sc1
L_epi1d:
    s_waitcnt lgkmcnt(0)
    v_mfma_f32_16x16x32_bf16 v[112:115], v[72:75], v[128:131], 0
    ds_read_b64_tr_b16 v[88:89], v16 offset:57344
    ds_read_b64_tr_b16 v[90:91], v16 offset:57856
    v_mfma_f32_16x16x32_bf16 v[116:119], v[76:79], v[128:131], 0
    ds_read_b64_tr_b16 v[92:93], v19 offset:57344
    ds_read_b64_tr_b16 v[94:95], v19 offset:57856
    v_mfma_f32_16x16x32_bf16 v[120:123], v[72:75], v[184:187], 0
    ds_read_b64_tr_b16 v[96:97], v16 offset:61440
    ds_read_b64_tr_b16 v[98:99], v16 offset:61952
    v_mfma_f32_16x16x32_bf16 v[124:127], v[76:79], v[184:187], 0
    ds_read_b64_tr_b16 v[100:101], v19 offset:61440
    ds_read_b64_tr_b16 v[102:103], v19 offset:61952
    s_add_u32 m0, s41, 0
    s_mul_i32 s52, s81, s0
    s_mov_b64 exec, 0xff
    buffer_load_dword v52, v14, s[28:31], s85 offen sc1
    s_mov_b64 exec, -1
    v_mfma_f32_16x16x32_bf16 v[112:115], v[80:83], v[132:135], v[112:115]
    buffer_load_dwordx4 v7, s[20:23], s52 offen lds
    v_mfma_f32_16x16x32_bf16 v[116:119], v[84:87], v[132:135], v[116:119]
    s_add_u32 m0, s41, 8192
    v_mfma_f32_16x16x32_bf16 v[120:123], v[80:83], v[188:191], v[120:123]
    buffer_load_dwordx4 v37, s[20:23], s52 offen lds
    v_mfma_f32_16x16x32_bf16 v[124:127], v[84:87], v[188:191], v[124:127]
    s_waitcnt lgkmcnt(0)
    s_waitcnt vmcnt(8)
    s_barrier
    v_mfma_f32_16x16x32_bf16 v[112:115], v[88:91], v[136:139], v[112:115]
    ds_read_b64_tr_b16 v[72:73], v17 offset:0
    ds_read_b64_tr_b16 v[74:75], v17 offset:512
    v_mfma_f32_16x16x32_bf16 v[116:119], v[92:95], v[136:139], v[116:119]
    ds_read_b64_tr_b16 v[76:77], v20 offset:0
    ds_read_b64_tr_b16 v[78:79], v20 offset:512
    v_mfma_f32_16x16x32_bf16 v[120:123], v[88:91], v[192:195], v[120:123]
    ds_read_b64_tr_b16 v[80:81], v17 offset:4096
    ds_read_b64_tr_b16 v[82:83], v17 offset:4608
    v_mfma_f32_16x16x32_bf16 v[124:127], v[92:95], v[192:195], v[124:127]
    ds_read_b64_tr_b16 v[84:85], v20 offset:4096
    ds_read_b64_tr_b16 v[86:87], v20 offset:4608
    v_mfma_f32_16x16x32_bf16 v[112:115], v[96:99], v[140:143], v[112:115]
    v_mfma_f32_16x16x32_bf16 v[116:119], v[100:103], v[140:143], v[116:119]
    v_mfma_f32_16x16x32_bf16 v[120:123], v[96:99], v[196:199], v[120:123]
    v_mfma_f32_16x16x32_bf16 v[124:127], v[100:103], v[196:199], v[124:127]
    s_waitcnt lgkmcnt(0)
    v_mfma_f32_16x16x32_bf16 v[112:115], v[72:75], v[144:147], v[112:115]
    ds_read_b64_tr_b16 v[88:89], v17 offset:8192
    ds_read_b64_tr_b16 v[90:91], v17 offset:8704
    v_mfma_f32_16x16x32_bf16 v[116:119], v[76:79], v[144:147], v[116:119]
    ds_read_b64_tr_b16 v[92:93], v20 offset:8192
    ds_read_b64_tr_b16 v[94:95], v20 offset:8704
    v_mfma_f32_16x16x32_bf16 v[120:123], v[72:75], v[200:203], v[120:123]
    ds_read_b64_tr_b16 v[96:97], v17 offset:12288
    ds_read_b64_tr_b16 v[98:99], v17 offset:12800
    v_mfma_f32_16x16x32_bf16 v[124:127], v[76:79], v[200:203], v[124:127]
    ds_read_b64_tr_b16 v[100:101], v20 offset:12288
    ds_read_b64_tr_b16 v[102:103], v20 offset:12800
    v_mfma_f32_16x16x32_bf16 v[112:115], v[80:83], v[148:151], v[112:115]
    v_mfma_f32_16x16x32_bf16 v[116:119], v[84:87], v[148:151], v[116:119]
    v_mfma_f32_16x16x32_bf16 v[120:123], v[80:83], v[204:207], v[120:123]
    v_mfma_f32_16x16x32_bf16 v[124:127], v[84:87], v[204:207], v[124:127]
    s_waitcnt lgkmcnt(0)
    s_add_u32 m0, s41, 49152
    s_mul_i32 s52, s59, s0
    buffer_load_dwordx4 v7, s[20:23], s52 offen lds
    s_add_u32 m0, s41, 57344
    s_mul_i32 s52, s4, s0
    buffer_load_dwordx4 v37, s[20:23], s52 offen lds
    s_add_u32 m0, s41, 65536
    s_mul_i32 s52, s60, s0
    buffer_load_dwordx4 v7, s[20:23], s52 offen lds
    s_add_u32 m0, s41, 73728
    s_mul_i32 s52, s54, s0
    buffer_load_dwordx4 v37, s[20:23], s52 offen lds
    s_and_b32 s56, s84, 0xff
    s_waitcnt vmcnt(6)
    v_cmp_ne_u32 vcc, s53, v52
    s_nop 0
    s_and_b32 s55, vcc_lo, s56
    s_cbranch_scc1 L_pq_slow
L_pq_back:
    s_barrier
    buffer_store_dword v39, v38, s[28:31], s96 offen offset:2048 sc1
    v_mfma_f32_16x16x32_bf16 v[112:115], v[88:91], v[152:155], v[112:115]
    ds_read_b64_tr_b16 v[72:73], v17 offset:16384
    ds_read_b64_tr_b16 v[74:75], v17 offset:16896
    s_movk_i32 s55, 16384
    buffer_load_dwordx4 v[48:51], v9, s[28:31], s55 offen sc1
    v_mfma_f32_16x16x32_bf16 v[116:119], v[92:95], v[152:155], v[116:119]
    ds_read_b64_tr_b16 v[76:77], v20 offset:16384
    ds_read_b64_tr_b16 v[78:79], v20 offset:16896
    buffer_load_dwordx4 v[44:47], v9, s[28:31], s63 offen sc1
    v_mfma_f32_16x16x32_bf16 v[120:123], v[88:91], v[208:211], v[120:123]
    ds_read_b64_tr_b16 v[80:81], v17 offset:20480
    ds_read_b64_tr_b16 v[82:83], v17 offset:20992
    buffer_load_dwordx4 v[40:43], v9, s[28:31], s3 offen sc1
    v_mfma_f32_16x16x32_bf16 v[124:127], v[92:95], v[208:211], v[124:127]
    ds_read_b64_tr_b16 v[84:85], v20 offset:20480
    ds_read_b64_tr_b16 v[86:87], v20 offset:20992
    buffer_load_dwordx2 v[248:249], v54, s[28:31], 0 offen sc1
    v_mfma_f32_16x16x32_bf16 v[112:115], v[96:99], v[156:159], v[112:115]
    v_mfma_f32_16x16x32_bf16 v[116:119], v[100:103], v[156:159], v[116:119]
    v_mfma_f32_16x16x32_bf16 v[120:123], v[96:99], v[212:215], v[120:123]
    v_mfma_f32_16x16x32_bf16 v[124:127], v[100:103], v[212:215], v[124:127]
    buffer_load_dwordx2 v[250:251], v55, s[28:31], 0 offen offset:1024 sc1
    s_waitcnt lgkmcnt(0)
    v_mfma_f32_16x16x32_bf16 v[112:115], v[72:75], v[160:163], v[112:115]
    ds_read_b64_tr_b16 v[88:89], v17 offset:24576
    ds_read_b64_tr_b16 v[90:91], v17 offset:25088
    v_mfma_f32_16x16x32_bf16 v[116:119], v[76:79], v[160:163], v[116:119]
    ds_read_b64_tr_b16 v[92:93], v20 offset:24576
    ds_read_b64_tr_b16 v[94:95], v20 offset:25088
    v_mfma_f32_16x16x32_bf16 v[120:123], v[72:75], v[216:219], v[120:123]
    ds_read_b64_tr_b16 v[96:97], v17 offset:28672
    ds_read_b64_tr_b16 v[98:99], v17 offset:29184
    v_mfma_f32_16x16x32_bf16 v[124:127], v[76:79], v[216:219], v[124:127]
    ds_read_b64_tr_b16 v[100:101], v20 offset:28672
    ds_read_b64_tr_b16 v[102:103], v20 offset:29184
    v_mfma_f32_16x16x32_bf16 v[112:115], v[80:83], v[164:167], v[112:115]
    s_add_u32 m0, s41, 81920
    s_mul_i32 s52, s61, s0
    v_mfma_f32_16x16x32_bf16 v[116:119], v[84:87], v[164:167], v[116:119]
    buffer_load_dwordx4 v7, s[20:23], s52 offen lds
    v_mfma_f32_16x16x32_bf16 v[120:123], v[80:83], v[220:223], v[120:123]
    v_mfma_f32_16x16x32_bf16 v[124:127], v[84:87], v[220:223], v[124:127]
    s_waitcnt lgkmcnt(0)
    v_mfma_f32_16x16x32_bf16 v[112:115], v[88:91], v[168:171], v[112:115]
    ds_read_b64_tr_b16 v[72:73], v16 offset:40960
    ds_read_b64_tr_b16 v[74:75], v16 offset:41472
    v_mfma_f32_16x16x32_bf16 v[116:119], v[92:95], v[168:171], v[116:119]
    ds_read_b64_tr_b16 v[76:77], v19 offset:40960
    ds_read_b64_tr_b16 v[78:79], v19 offset:41472
    v_mfma_f32_16x16x32_bf16 v[120:123], v[88:91], v[224:227], v[120:123]
    ds_read_b64_tr_b16 v[80:81], v16 offset:45056
    ds_read_b64_tr_b16 v[82:83], v16 offset:45568
    v_mfma_f32_16x16x32_bf16 v[124:127], v[92:95], v[224:227], v[124:127]
    ds_read_b64_tr_b16 v[84:85], v19 offset:45056
    ds_read_b64_tr_b16 v[86:87], v19 offset:45568
    v_mfma_f32_16x16x32_bf16 v[112:115], v[96:99], v[172:175], v[112:115]
    s_add_u32 m0, s41, 90112
    v_mfma_f32_16x16x32_bf16 v[116:119], v[100:103], v[172:175], v[116:119]
    buffer_load_dwordx4 v37, s[20:23], s52 offen lds
    v_mfma_f32_16x16x32_bf16 v[120:123], v[96:99], v[228:231], v[120:123]
    v_mfma_f32_16x16x32_bf16 v[124:127], v[100:103], v[228:231], v[124:127]
    s_waitcnt lgkmcnt(0)
    v_mfma_f32_16x16x32_bf16 v[112:115], v[72:75], v[176:179], v[112:115]
    v_mfma_f32_16x16x32_bf16 v[116:119], v[76:79], v[176:179], v[116:119]
    v_mfma_f32_16x16x32_bf16 v[120:123], v[72:75], v[232:235], v[120:123]
    s_waitcnt vmcnt(6)
    ds_write2st64_b64 v53, v[48:49], v[50:51] offset0:32 offset1:34
    v_mfma_f32_16x16x32_bf16 v[124:127], v[76:79], v[232:235], v[124:127]
    v_mfma_f32_16x16x32_bf16 v[112:115], v[80:83], v[180:183], v[112:115]
    s_add_u32 m0, s41, 98304
    s_mul_i32 s52, s62, s0
    s_waitcnt vmcnt(5)
    s_lshr_b32 s55, s63, 15
    v_and_or_b32 v44, v10, s55, v44
    v_and_or_b32 v46, v10, s55, v46
    ds_write2st64_b64 v53, v[44:45], v[46:47] offset0:16 offset1:18
    v_mfma_f32_16x16x32_bf16 v[116:119], v[84:87], v[180:183], v[116:119]
    buffer_load_dwordx4 v7, s[20:23], s52 offen lds
    v_mfma_f32_16x16x32_bf16 v[120:123], v[80:83], v[236:239], v[120:123]
    s_waitcnt vmcnt(5)
    s_lshr_b32 s55, s3, 15
    v_and_or_b32 v40, v10, s55, v40
    v_and_or_b32 v42, v10, s55, v42
    ds_write2st64_b64 v53, v[40:41], v[42:43] offset0:0 offset1:2
    v_mfma_f32_16x16x32_bf16 v[124:127], v[84:87], v[236:239], v[124:127]
    v_cvt_pk_bf16_f32 v104, v112, v113
    v_cvt_pk_bf16_f32 v105, v114, v115
    v_pk_max_i16 v104, v104, 0
    v_pk_max_i16 v105, v105, 0
    v_cvt_pk_bf16_f32 v106, v116, v117
    v_cvt_pk_bf16_f32 v107, v118, v119
    v_pk_max_i16 v106, v106, 0
    v_pk_max_i16 v107, v107, 0
    buffer_store_dwordx4 v[104:107], v60, s[28:31], 0 offen sc1
    v_cvt_pk_bf16_f32 v108, v120, v121
    v_cvt_pk_bf16_f32 v109, v122, v123
    v_pk_max_i16 v108, v108, 0
    v_pk_max_i16 v109, v109, 0
    v_cvt_pk_bf16_f32 v110, v124, v125
    v_cvt_pk_bf16_f32 v111, v126, v127
    v_pk_max_i16 v110, v110, 0
    v_pk_max_i16 v111, v111, 0
    buffer_store_dwordx4 v[108:111], v61, s[28:31], 0 offen sc1
    v_cmp_lt_u32 vcc, 47, v1
    v_mov_b32 v33, 0x3f80
    s_waitcnt vmcnt(5)
    v_cndmask_b32 v250, v250, v33, vcc
    s_cmp_lg_u32 s91, 0
    s_cbranch_scc1 L_helper
    s_waitcnt lgkmcnt(0)
    s_barrier
    ds_read_b128 v[108:111], v4 offset:0
    ds_read_b128 v[112:115], v4 offset:1024
    ds_read_b128 v[116:119], v4 offset:2048
    v_subrev_u32 v15, s87, v7
    v_add_u32 v16, 50176, v15
    s_waitcnt lgkmcnt(2)
    v_mfma_f32_16x16x32_bf16 v[40:43], v[108:111], v[248:251], v[240:243]
    ds_read_b128 v[108:111], v4 offset:3072
    s_waitcnt lgkmcnt(2)
    v_mfma_f32_16x16x32_bf16 v[44:47], v[112:115], v[248:251], 0
    ds_read_b128 v[112:115], v4 offset:4096
    s_mov_b64 exec, 0x3f00
    buffer_load_dword v5, v14, s[28:31], s85 offen sc1
    s_mov_b64 exec, -1
    s_mov_b64 exec, 0x3ff
    buffer_load_dword v6, v12, s[28:31], s85 offen sc1
    s_mov_b64 exec, -1
    s_waitcnt lgkmcnt(2)
    v_mfma_f32_16x16x32_bf16 v[48:51], v[116:119], v[248:251], 0
    ds_read_b128 v[116:119], v4 offset:5120
    s_add_u32 m0, s41, 106496
    s_nop 0
    buffer_load_dwordx4 v37, s[20:23], s52 offen lds
    s_waitcnt lgkmcnt(2)
    v_mfma_f32_16x16x32_bf16 v[52:55], v[108:111], v[248:251], 0
    ds_read_b128 v[108:111], v4 offset:6144
    v_max3_f32 v35, v40, v41, v42
    v_max_f32 v35, v35, v43
    s_waitcnt lgkmcnt(2)
    v_mfma_f32_16x16x32_bf16 v[56:59], v[112:115], v[248:251], 0
    ds_read_b128 v[112:115], v4 offset:7168
    v_max3_f32 v35, v35, v44, v45
    v_max3_f32 v35, v35, v46, v47
    s_waitcnt lgkmcnt(2)
    v_mfma_f32_16x16x32_bf16 v[60:63], v[116:119], v[248:251], 0
    ds_read_b128 v[116:119], v4 offset:8192
    s_mul_i32 s52, s83, s0
    buffer_load_dwordx4 v[208:211], v7, s[20:23], s52 offen
    v_max3_f32 v35, v35, v48, v49
    v_max3_f32 v35, v35, v50, v51
    s_waitcnt lgkmcnt(2)
    v_mfma_f32_16x16x32_bf16 v[64:67], v[108:111], v[248:251], 0
    ds_read_b128 v[108:111], v4 offset:9216
    v_max3_f32 v35, v35, v52, v53
    v_max3_f32 v35, v35, v54, v55
    s_waitcnt lgkmcnt(2)
    v_mfma_f32_16x16x32_bf16 v[68:71], v[112:115], v[248:251], 0
    ds_read_b128 v[112:115], v4 offset:10240
    v_max3_f32 v35, v35, v56, v57
    v_max3_f32 v35, v35, v58, v59
    s_waitcnt lgkmcnt(2)
    v_mfma_f32_16x16x32_bf16 v[72:75], v[116:119], v[248:251], 0
    ds_read_b128 v[116:119], v4 offset:11264
    buffer_load_dwordx4 v[212:215], v37, s[20:23], s52 offen
    v_max3_f32 v35, v35, v60, v61
    v_max3_f32 v35, v35, v62, v63
    s_waitcnt lgkmcnt(2)
    v_mfma_f32_16x16x32_bf16 v[76:79], v[108:111], v[248:251], 0
    ds_read_b128 v[108:111], v4 offset:12288
    v_max3_f32 v35, v35, v64, v65
    v_max3_f32 v35, v35, v66, v67
    s_waitcnt lgkmcnt(2)
    v_mfma_f32_16x16x32_bf16 v[80:83], v[112:115], v[248:251], 0
    ds_read_b128 v[112:115], v4 offset:13312
    v_max3_f32 v35, v35, v68, v69
    v_max3_f32 v35, v35, v70, v71
    s_waitcnt lgkmcnt(2)
    v_mfma_f32_16x16x32_bf16 v[84:87], v[116:119], v[248:251], 0
    ds_read_b128 v[116:119], v4 offset:14336
    s_mul_i32 s52, s100, s0
    buffer_load_dwordx4 v[216:219], v7, s[20:23], s52 offen
    v_max3_f32 v35, v35, v72, v73
    v_max3_f32 v35, v35, v74, v75
    s_waitcnt lgkmcnt(2)
    v_mfma_f32_16x16x32_bf16 v[88:91], v[108:111], v[248:251], 0
    ds_read_b128 v[108:111], v4 offset:15360
    v_max3_f32 v35, v35, v76, v77
    v_max3_f32 v35, v35, v78, v79
    s_waitcnt lgkmcnt(2)
    v_mfma_f32_16x16x32_bf16 v[92:95], v[112:115], v[248:251], 0
    ds_read_b128 v[112:115], v4 offset:16384
    v_max3_f32 v35, v35, v80, v81
    v_max3_f32 v35, v35, v82, v83
    s_waitcnt lgkmcnt(2)
    v_mfma_f32_16x16x32_bf16 v[96:99], v[116:119], v[248:251], 0
    buffer_load_dwordx4 v[220:223], v37, s[20:23], s52 offen
    v_max3_f32 v35, v35, v84, v85
    v_max3_f32 v35, v35, v86, v87
    s_waitcnt lgkmcnt(1)
    v_mfma_f32_16x16x32_bf16 v[100:103], v[108:111], v[248:251], 0
    v_max3_f32 v35, v35, v88, v89
    v_max3_f32 v35, v35, v90, v91
    s_waitcnt lgkmcnt(0)
    v_mfma_f32_16x16x32_bf16 v[104:107], v[112:115], v[248:251], v[244:247]
    v_max3_f32 v35, v35, v92, v93
    v_max3_f32 v35, v35, v94, v95
    v_max3_f32 v35, v35, v96, v97
    v_max3_f32 v35, v35, v98, v99
    v_max3_f32 v35, v35, v100, v101
    v_max3_f32 v35, v35, v102, v103
    s_nop 1
    v_max3_f32 v35, v35, v104, v105
    v_max3_f32 v35, v35, v106, v107
    v_mov_b32 v33, v35
    s_nop 1
    v_permlane32_swap_b32 v33, v35
    v_max_f32 v35, v35, v33
    v_mov_b32 v33, v35
    s_nop 1
    v_permlane16_swap_b32 v33, v35
    v_max_f32 v35, v35, v33
    v_mul_f32 v36, v35, v8
    v_pk_fma_f32 v[40:41], v[40:41], v[8:9], v[36:37] op_sel_hi:[1,0,0] neg_lo:[0,0,1] neg_hi:[0,0,1]
    v_pk_fma_f32 v[42:43], v[42:43], v[8:9], v[36:37] op_sel_hi:[1,0,0] neg_lo:[0,0,1] neg_hi:[0,0,1]
    v_pk_fma_f32 v[44:45], v[44:45], v[8:9], v[36:37] op_sel_hi:[1,0,0] neg_lo:[0,0,1] neg_hi:[0,0,1]
    v_pk_fma_f32 v[46:47], v[46:47], v[8:9], v[36:37] op_sel_hi:[1,0,0] neg_lo:[0,0,1] neg_hi:[0,0,1]
    v_exp_f32 v40, v40
    v_exp_f32 v41, v41
    v_exp_f32 v42, v42
    s_mov_b32 s52, 1490944
    buffer_load_dwordx4 v[224:227], v7, s[20:23], s52 offen
    v_exp_f32 v43, v43
    v_exp_f32 v44, v44
    v_exp_f32 v45, v45
    v_exp_f32 v46, v46
    buffer_load_dwordx4 v[228:231], v37, s[20:23], s52 offen
    v_exp_f32 v47, v47
    v_cvt_pk_bf16_f32 v40, v40, v41
    v_cvt_pk_bf16_f32 v41, v42, v43
    v_cvt_pk_bf16_f32 v42, v44, v45
    v_cvt_pk_bf16_f32 v43, v46, v47
    s_and_b32 s56, s84, 0x3f00
    s_waitcnt vmcnt(8)
    v_cmp_ne_u32 vcc, s53, v5
    s_nop 0
    s_and_b32 s55, vcc_lo, s56
    s_cbranch_scc1 L_pv_slow
L_pv_back:
    s_and_b32 s56, s84, 0x3ff
    s_waitcnt vmcnt(7)
    v_cmp_ne_u32 vcc, s53, v6
    s_nop 0
    s_and_b32 s55, vcc_lo, s56
    s_cbranch_scc1 L_pe_slow
L_pe_back:
    s_barrier
    s_add_u32 s55, s96, 4096
    buffer_store_dword v39, v38, s[28:31], s55 offen offset:0 sc1
    s_mov_b32 s55, 2113536
    buffer_load_dwordx4 v[252:255], v9, s[28:31], s55 offen sc1
    s_add_u32 s55, s63, 2097152
    buffer_load_dwordx4 v[124:127], v9, s[28:31], s55 offen sc1
    s_add_u32 s55, s3, 2097152
    buffer_load_dwordx4 v[120:123], v9, s[28:31], s55 offen sc1
    buffer_load_dwordx4 v[128:131], v0, s[28:31], s58 offen sc1
    buffer_load_dwordx4 v[132:135], v13, s[28:31], s58 offen sc1
    v_pk_fma_f32 v[48:49], v[48:49], v[8:9], v[36:37] op_sel_hi:[1,0,0] neg_lo:[0,0,1] neg_hi:[0,0,1]
    v_pk_fma_f32 v[50:51], v[50:51], v[8:9], v[36:37] op_sel_hi:[1,0,0] neg_lo:[0,0,1] neg_hi:[0,0,1]
    v_pk_fma_f32 v[52:53], v[52:53], v[8:9], v[36:37] op_sel_hi:[1,0,0] neg_lo:[0,0,1] neg_hi:[0,0,1]
    v_pk_fma_f32 v[54:55], v[54:55], v[8:9], v[36:37] op_sel_hi:[1,0,0] neg_lo:[0,0,1] neg_hi:[0,0,1]
    v_exp_f32 v48, v48
    v_exp_f32 v49, v49
    v_exp_f32 v50, v50
    v_exp_f32 v51, v51
    v_exp_f32 v52, v52
    v_exp_f32 v53, v53
    v_exp_f32 v54, v54
    v_exp_f32 v55, v55
    v_cvt_pk_bf16_f32 v48, v48, v49
    v_cvt_pk_bf16_f32 v49, v50, v51
    v_cvt_pk_bf16_f32 v50, v52, v53
    v_cvt_pk_bf16_f32 v51, v54, v55
    v_pk_fma_f32 v[56:57], v[56:57], v[8:9], v[36:37] op_sel_hi:[1,0,0] neg_lo:[0,0,1] neg_hi:[0,0,1]
    v_pk_fma_f32 v[58:59], v[58:59], v[8:9], v[36:37] op_sel_hi:[1,0,0] neg_lo:[0,0,1] neg_hi:[0,0,1]
    v_pk_fma_f32 v[60:61], v[60:61], v[8:9], v[36:37] op_sel_hi:[1,0,0] neg_lo:[0,0,1] neg_hi:[0,0,1]
    v_pk_fma_f32 v[62:63], v[62:63], v[8:9], v[36:37] op_sel_hi:[1,0,0] neg_lo:[0,0,1] neg_hi:[0,0,1]
    v_exp_f32 v56, v56
    v_exp_f32 v57, v57
    v_exp_f32 v58, v58
    v_exp_f32 v59, v59
    v_exp_f32 v60, v60
    v_exp_f32 v61, v61
    v_exp_f32 v62, v62
    v_exp_f32 v63, v63
    v_cvt_pk_bf16_f32 v56, v56, v57
    v_cvt_pk_bf16_f32 v57, v58, v59
    v_cvt_pk_bf16_f32 v58, v60, v61
    v_cvt_pk_bf16_f32 v59, v62, v63
    v_pk_fma_f32 v[64:65], v[64:65], v[8:9], v[36:37] op_sel_hi:[1,0,0] neg_lo:[0,0,1] neg_hi:[0,0,1]
    v_pk_fma_f32 v[66:67], v[66:67], v[8:9], v[36:37] op_sel_hi:[1,0,0] neg_lo:[0,0,1] neg_hi:[0,0,1]
    v_pk_fma_f32 v[68:69], v[68:69], v[8:9], v[36:37] op_sel_hi:[1,0,0] neg_lo:[0,0,1] neg_hi:[0,0,1]
    v_pk_fma_f32 v[70:71], v[70:71], v[8:9], v[36:37] op_sel_hi:[1,0,0] neg_lo:[0,0,1] neg_hi:[0,0,1]
    v_exp_f32 v64, v64
    v_exp_f32 v65, v65
    v_exp_f32 v66, v66
    v_exp_f32 v67, v67
    v_exp_f32 v68, v68
    v_exp_f32 v69, v69
    v_exp_f32 v70, v70
    v_exp_f32 v71, v71
    v_cvt_pk_bf16_f32 v64, v64, v65
    v_cvt_pk_bf16_f32 v65, v66, v67
    v_cvt_pk_bf16_f32 v66, v68, v69
    v_cvt_pk_bf16_f32 v67, v70, v71
    v_pk_fma_f32 v[72:73], v[72:73], v[8:9], v[36:37] op_sel_hi:[1,0,0] neg_lo:[0,0,1] neg_hi:[0,0,1]
    v_pk_fma_f32 v[74:75], v[74:75], v[8:9], v[36:37] op_sel_hi:[1,0,0] neg_lo:[0,0,1] neg_hi:[0,0,1]
    v_pk_fma_f32 v[76:77], v[76:77], v[8:9], v[36:37] op_sel_hi:[1,0,0] neg_lo:[0,0,1] neg_hi:[0,0,1]
    v_pk_fma_f32 v[78:79], v[78:79], v[8:9], v[36:37] op_sel_hi:[1,0,0] neg_lo:[0,0,1] neg_hi:[0,0,1]
    v_exp_f32 v72, v72
    v_exp_f32 v73, v73
    v_exp_f32 v74, v74
    buffer_load_dwordx4 v[136:139], v0, s[28:31], s59 offen sc1
    v_exp_f32 v75, v75
    v_exp_f32 v76, v76
    v_exp_f32 v77, v77
    v_exp_f32 v78, v78
    buffer_load_dwordx4 v[140:143], v13, s[28:31], s59 offen sc1
    v_exp_f32 v79, v79
    v_cvt_pk_bf16_f32 v72, v72, v73
    v_cvt_pk_bf16_f32 v73, v74, v75
    v_cvt_pk_bf16_f32 v74, v76, v77
    v_cvt_pk_bf16_f32 v75, v78, v79
    v_pk_fma_f32 v[80:81], v[80:81], v[8:9], v[36:37] op_sel_hi:[1,0,0] neg_lo:[0,0,1] neg_hi:[0,0,1]
    v_pk_fma_f32 v[82:83], v[82:83], v[8:9], v[36:37] op_sel_hi:[1,0,0] neg_lo:[0,0,1] neg_hi:[0,0,1]
    v_pk_fma_f32 v[84:85], v[84:85], v[8:9], v[36:37] op_sel_hi:[1,0,0] neg_lo:[0,0,1] neg_hi:[0,0,1]
    v_pk_fma_f32 v[86:87], v[86:87], v[8:9], v[36:37] op_sel_hi:[1,0,0] neg_lo:[0,0,1] neg_hi:[0,0,1]
    v_exp_f32 v80, v80
    v_exp_f32 v81, v81
    v_exp_f32 v82, v82
    buffer_load_dwordx4 v[144:147], v0, s[28:31], s60 offen sc1
    v_exp_f32 v83, v83
    v_exp_f32 v84, v84
    v_exp_f32 v85, v85
    v_exp_f32 v86, v86
    buffer_load_dwordx4 v[148:151], v13, s[28:31], s60 offen sc1
    v_exp_f32 v87, v87
    v_cvt_pk_bf16_f32 v80, v80, v81
    v_cvt_pk_bf16_f32 v81, v82, v83
    v_cvt_pk_bf16_f32 v82, v84, v85
    v_cvt_pk_bf16_f32 v83, v86, v87
    s_movk_i32 s55, 0x3f80
    s_waitcnt vmcnt(8)
    v_and_or_b32 v252, v10, s55, v252
    v_and_or_b32 v254, v10, s55, v254
    ds_write2st64_b64 v3, v[252:253], v[254:255] offset0:32 offset1:34
    s_waitcnt vmcnt(7)
    v_and_or_b32 v124, v10, s55, v124
    v_and_or_b32 v126, v10, s55, v126
    ds_write2st64_b64 v3, v[124:125], v[126:127] offset0:16 offset1:18
    s_waitcnt vmcnt(6)
    v_and_or_b32 v120, v10, s55, v120
    v_and_or_b32 v122, v10, s55, v122
    ds_write2st64_b64 v3, v[120:121], v[122:123] offset0:0 offset1:2
    s_waitcnt lgkmcnt(0)
    s_barrier
    ds_read_b64_tr_b16 v[108:109], v11 offset:0
    ds_read_b64_tr_b16 v[110:111], v11 offset:1024
    ds_read_b64_tr_b16 v[112:113], v11 offset:512
    ds_read_b64_tr_b16 v[114:115], v11 offset:1536
    ds_read_b64_tr_b16 v[240:241], v11 offset:2048
    ds_read_b64_tr_b16 v[242:243], v11 offset:3072
    ds_read_b64_tr_b16 v[244:245], v11 offset:2560
    ds_read_b64_tr_b16 v[246:247], v11 offset:3584
    v_pk_fma_f32 v[88:89], v[88:89], v[8:9], v[36:37] op_sel_hi:[1,0,0] neg_lo:[0,0,1] neg_hi:[0,0,1]
    v_pk_fma_f32 v[90:91], v[90:91], v[8:9], v[36:37] op_sel_hi:[1,0,0] neg_lo:[0,0,1] neg_hi:[0,0,1]
    v_pk_fma_f32 v[92:93], v[92:93], v[8:9], v[36:37] op_sel_hi:[1,0,0] neg_lo:[0,0,1] neg_hi:[0,0,1]
    v_pk_fma_f32 v[94:95], v[94:95], v[8:9], v[36:37] op_sel_hi:[1,0,0] neg_lo:[0,0,1] neg_hi:[0,0,1]
    v_exp_f32 v88, v88
    v_exp_f32 v89, v89
    v_exp_f32 v90, v90
    buffer_load_dwordx4 v[152:155], v0, s[28:31], s61 offen sc1
    v_exp_f32 v91, v91
    v_exp_f32 v92, v92
    v_exp_f32 v93, v93
    v_exp_f32 v94, v94
    buffer_load_dwordx4 v[156:159], v13, s[28:31], s61 offen sc1
    v_exp_f32 v95, v95
    v_cvt_pk_bf16_f32 v88, v88, v89
    v_cvt_pk_bf16_f32 v89, v90, v91
    v_cvt_pk_bf16_f32 v90, v92, v93
    v_cvt_pk_bf16_f32 v91, v94, v95
    s_waitcnt lgkmcnt(4)
    v_mfma_f32_16x16x32_bf16 v[120:123], v[108:111], v[40:43], 0
    v_mfma_f32_16x16x32_bf16 v[124:127], v[112:115], v[40:43], 0
    ds_read_b64_tr_b16 v[108:109], v11 offset:4096
    ds_read_b64_tr_b16 v[110:111], v11 offset:5120
    ds_read_b64_tr_b16 v[112:113], v11 offset:4608
    ds_read_b64_tr_b16 v[114:115], v11 offset:5632
    buffer_load_dwordx4 v[160:163], v0, s[28:31], s62 offen sc1
    s_waitcnt lgkmcnt(4)
    v_mfma_f32_16x16x32_bf16 v[120:123], v[240:243], v[48:51], v[120:123]
    v_mfma_f32_16x16x32_bf16 v[124:127], v[244:247], v[48:51], v[124:127]
    ds_read_b64_tr_b16 v[240:241], v11 offset:6144
    ds_read_b64_tr_b16 v[242:243], v11 offset:7168
    ds_read_b64_tr_b16 v[244:245], v11 offset:6656
    ds_read_b64_tr_b16 v[246:247], v11 offset:7680
    buffer_load_dwordx4 v[164:167], v13, s[28:31], s62 offen sc1
    s_waitcnt lgkmcnt(4)
    v_mfma_f32_16x16x32_bf16 v[120:123], v[108:111], v[56:59], v[120:123]
    v_mfma_f32_16x16x32_bf16 v[124:127], v[112:115], v[56:59], v[124:127]
    ds_read_b64_tr_b16 v[108:109], v11 offset:8192
    ds_read_b64_tr_b16 v[110:111], v11 offset:9216
    ds_read_b64_tr_b16 v[112:113], v11 offset:8704
    ds_read_b64_tr_b16 v[114:115], v11 offset:9728
    s_add_u32 m0, s41, 114688
    s_mul_i32 s52, s82, s0
    buffer_load_dwordx4 v7, s[20:23], s52 offen lds
    s_mov_b64 exec, 0x3fffc00
    buffer_load_dword v116, v12, s[28:31], s85 offen sc1
    s_mov_b64 exec, -1
    v_pk_fma_f32 v[96:97], v[96:97], v[8:9], v[36:37] op_sel_hi:[1,0,0] neg_lo:[0,0,1] neg_hi:[0,0,1]
    v_pk_fma_f32 v[98:99], v[98:99], v[8:9], v[36:37] op_sel_hi:[1,0,0] neg_lo:[0,0,1] neg_hi:[0,0,1]
    v_pk_fma_f32 v[100:101], v[100:101], v[8:9], v[36:37] op_sel_hi:[1,0,0] neg_lo:[0,0,1] neg_hi:[0,0,1]
    v_pk_fma_f32 v[102:103], v[102:103], v[8:9], v[36:37] op_sel_hi:[1,0,0] neg_lo:[0,0,1] neg_hi:[0,0,1]
    v_exp_f32 v96, v96
    v_exp_f32 v97, v97
    v_exp_f32 v98, v98
    s_add_u32 m0, s41, 122880
    s_nop 0
    buffer_load_dwordx4 v37, s[20:23], s52 offen lds
    v_exp_f32 v99, v99
    v_exp_f32 v100, v100
    v_exp_f32 v101, v101
    v_exp_f32 v102, v102
    s_mul_i32 s52, s93, 49
    s_lshr_b32 s52, s52, 1
    buffer_load_dwordx4 v[232:235], v15, s[24:27], s52 offen
    v_exp_f32 v103, v103
    v_cvt_pk_bf16_f32 v96, v96, v97
    v_cvt_pk_bf16_f32 v97, v98, v99
    v_cvt_pk_bf16_f32 v98, v100, v101
    v_cvt_pk_bf16_f32 v99, v102, v103
    s_waitcnt lgkmcnt(4)
    v_mfma_f32_16x16x32_bf16 v[120:123], v[240:243], v[64:67], v[120:123]
    v_mfma_f32_16x16x32_bf16 v[124:127], v[244:247], v[64:67], v[124:127]
    ds_read_b64_tr_b16 v[240:241], v11 offset:10240
    ds_read_b64_tr_b16 v[242:243], v11 offset:11264
    ds_read_b64_tr_b16 v[244:245], v11 offset:10752
    ds_read_b64_tr_b16 v[246:247], v11 offset:11776
    buffer_load_dwordx4 v[236:239], v16, s[24:27], s52 offen
    s_waitcnt lgkmcnt(4)
    v_mfma_f32_16x16x32_bf16 v[120:123], v[108:111], v[72:75], v[120:123]
    v_mfma_f32_16x16x32_bf16 v[124:127], v[112:115], v[72:75], v[124:127]
    ds_read_b64_tr_b16 v[108:109], v11 offset:12288
    ds_read_b64_tr_b16 v[110:111], v11 offset:13312
    ds_read_b64_tr_b16 v[112:113], v11 offset:12800
    ds_read_b64_tr_b16 v[114:115], v11 offset:13824
    s_waitcnt lgkmcnt(4)
    v_mfma_f32_16x16x32_bf16 v[120:123], v[240:243], v[80:83], v[120:123]
    v_mfma_f32_16x16x32_bf16 v[124:127], v[244:247], v[80:83], v[124:127]
    ds_read_b64_tr_b16 v[240:241], v11 offset:14336
    ds_read_b64_tr_b16 v[242:243], v11 offset:15360
    ds_read_b64_tr_b16 v[244:245], v11 offset:14848
    ds_read_b64_tr_b16 v[246:247], v11 offset:15872
    v_pk_fma_f32 v[104:105], v[104:105], v[8:9], v[36:37] op_sel_hi:[1,0,0] neg_lo:[0,0,1] neg_hi:[0,0,1]
    v_pk_fma_f32 v[106:107], v[106:107], v[8:9], v[36:37] op_sel_hi:[1,0,0] neg_lo:[0,0,1] neg_hi:[0,0,1]
    v_exp_f32 v104, v104
    v_exp_f32 v105, v105
    v_exp_f32 v106, v106
    v_exp_f32 v107, v107
    v_cvt_pk_bf16_f32 v104, v104, v105
    v_cvt_pk_bf16_f32 v105, v106, v107
    s_waitcnt lgkmcnt(4)
    v_mfma_f32_16x16x32_bf16 v[120:123], v[108:111], v[88:91], v[120:123]
    v_mfma_f32_16x16x32_bf16 v[124:127], v[112:115], v[88:91], v[124:127]
    ds_read_b64_tr_b16 v[108:109], v11 offset:16384
    ds_read_b64_tr_b16 v[112:113], v11 offset:16896
    s_waitcnt lgkmcnt(2)
    v_mfma_f32_16x16x32_bf16 v[120:123], v[240:243], v[96:99], v[120:123]
    v_mfma_f32_16x16x32_bf16 v[124:127], v[244:247], v[96:99], v[124:127]
    s_waitcnt lgkmcnt(0)
    v_mfma_f32_16x16x16_bf16 v[120:123], v[108:109], v[104:105], v[120:123]
    v_mfma_f32_16x16x16_bf16 v[124:127], v[112:113], v[104:105], v[124:127]
    ds_read_b64_tr_b16 v[40:41], v21 offset:32768
    ds_read_b64_tr_b16 v[42:43], v21 offset:34816
    ds_read_b64_tr_b16 v[44:45], v24 offset:32768
    ds_read_b64_tr_b16 v[46:47], v24 offset:34816
    ds_read_b64_tr_b16 v[48:49], v27 offset:32768
    ds_read_b64_tr_b16 v[50:51], v27 offset:34816
    ds_read_b64_tr_b16 v[52:53], v30 offset:32768
    ds_read_b64_tr_b16 v[54:55], v30 offset:34816
    ds_read_b64_tr_b16 v[56:57], v21 offset:49152
    ds_read_b64_tr_b16 v[58:59], v21 offset:51200
    ds_read_b64_tr_b16 v[60:61], v24 offset:49152
    ds_read_b64_tr_b16 v[62:63], v24 offset:51200
    ds_read_b64_tr_b16 v[64:65], v27 offset:49152
    ds_read_b64_tr_b16 v[66:67], v27 offset:51200
    ds_read_b64_tr_b16 v[68:69], v30 offset:49152
    ds_read_b64_tr_b16 v[70:71], v30 offset:51200
    v_mov_b32 v33, v124
    v_mov_b32 v34, v124
    s_nop 1
    v_permlane32_swap_b32 v33, v34
    v_mov_b32 v33, v34
    v_cmp_lt_u32 vcc, 47, v1
    s_nop 0
    v_permlane16_swap_b32 v33, v34
    v_rcp_f32 v34, v34
    s_nop 0
    v_cndmask_b32_e64 v33, v34, 0, vcc
    v_mul_f32 v120, v120, v34
    v_mul_f32 v121, v121, v34
    v_mul_f32 v122, v122, v34
    v_mul_f32 v123, v123, v34
    v_mul_f32 v124, v124, v33
    v_mul_f32 v125, v125, v33
    v_mul_f32 v126, v126, v33
    v_mul_f32 v127, v127, v33
    v_cvt_pk_bf16_f32 v120, v120, v121
    v_cvt_pk_bf16_f32 v121, v122, v123
    v_cvt_pk_bf16_f32 v122, v124, v125
    v_cvt_pk_bf16_f32 v123, v126, v127
    buffer_store_dwordx4 v[120:123], v2, s[28:31], s1 offen sc1
    v_add_u32 v112, s41, v2
    v_add_u32 v113, 0x10000, v112
    s_waitcnt lgkmcnt(8)
    s_and_b32 s56, s84, 0x3fffc00
    s_waitcnt vmcnt(4)
    v_cmp_ne_u32 vcc, s53, v116
    s_nop 0
    s_and_b32 s55, vcc_lo, s56
    s_cbranch_scc1 L_pl_slow
L_pl_back:
    s_barrier
    v_mfma_f32_16x16x32_bf16 v[72:75], v[40:43], v[128:131], 0
    ds_write_b128 v112, v[208:211] offset:32768
    ds_read_b64_tr_b16 v[240:241], v22 offset:0
    v_lshl_add_u32 v104, v1, 7, s88
    v_mfma_f32_16x16x32_bf16 v[76:79], v[44:47], v[128:131], 0
    ds_read_b64_tr_b16 v[242:243], v22 offset:2048
    buffer_load_dwordx4 v[168:171], v0, s[28:31], s80 offen sc1
    v_mfma_f32_16x16x32_bf16 v[80:83], v[48:51], v[128:131], 0
    ds_write_b128 v112, v[212:215] offset:40960
    ds_read_b64_tr_b16 v[244:245], v25 offset:0
    v_add_u32 v17, 57344, v0
    v_mfma_f32_16x16x32_bf16 v[84:87], v[52:55], v[128:131], 0
    ds_write_b128 v4, v[216:219] offset:16384
    ds_read_b64_tr_b16 v[246:247], v25 offset:2048
    v_add_u32 v18, 57344, v13
    v_mfma_f32_16x16x32_bf16 v[88:91], v[40:43], v[132:135], 0
    ds_read_b64_tr_b16 v[248:249], v28 offset:0
    buffer_load_dwordx4 v[172:175], v13, s[28:31], s80 offen sc1
    v_mfma_f32_16x16x32_bf16 v[92:95], v[44:47], v[132:135], 0
    ds_write_b128 v4, v[220:223] offset:24576
    ds_read_b64_tr_b16 v[250:251], v28 offset:2048
    v_and_b32 v115, 15, v1
    v_mfma_f32_16x16x32_bf16 v[96:99], v[48:51], v[132:135], 0
    ds_read_b64_tr_b16 v[252:253], v31 offset:0
    buffer_load_dwordx4 v[176:179], v0, s[28:31], s81 offen sc1
    v_mfma_f32_16x16x32_bf16 v[100:103], v[52:55], v[132:135], 0
    ds_read_b64_tr_b16 v[254:255], v31 offset:2048
    v_lshlrev_b32 v114, 2, v115
    s_waitcnt lgkmcnt(12)
    v_mfma_f32_16x16x32_bf16 v[72:75], v[56:59], v[136:139], v[72:75]
    ds_write_b128 v4, v[224:227] offset:32768
    ds_read_b64_tr_b16 v[40:41], v22 offset:16384
    v_add_u32 v114, 196608, v114
    v_mfma_f32_16x16x32_bf16 v[76:79], v[60:63], v[136:139], v[76:79]
    ds_read_b64_tr_b16 v[42:43], v22 offset:18432
    buffer_load_dwordx4 v[180:183], v13, s[28:31], s81 offen sc1
    v_mfma_f32_16x16x32_bf16 v[80:83], v[64:67], v[136:139], v[80:83]
    ds_write_b128 v4, v[228:231] offset:40960
    ds_read_b64_tr_b16 v[44:45], v25 offset:16384
    s_lshl_b32 s6, s6, 6
    v_mfma_f32_16x16x32_bf16 v[84:87], v[68:71], v[136:139], v[84:87]
    ds_read_b64_tr_b16 v[46:47], v25 offset:18432
    v_mul_u32_u24 v115, 896, v115
    v_mfma_f32_16x16x32_bf16 v[88:91], v[56:59], v[140:143], v[88:91]
    ds_read_b64_tr_b16 v[48:49], v28 offset:16384
    buffer_load_dwordx4 v[184:187], v0, s[28:31], s82 offen sc1
    v_mfma_f32_16x16x32_bf16 v[92:95], v[60:63], v[140:143], v[92:95]
    ds_read_b64_tr_b16 v[50:51], v28 offset:18432
    v_bfe_u32 v36, v1, 4, 1
    v_mfma_f32_16x16x32_bf16 v[96:99], v[64:67], v[140:143], v[96:99]
    ds_read_b64_tr_b16 v[52:53], v31 offset:16384
    buffer_load_dwordx4 v[188:191], v13, s[28:31], s82 offen sc1
    v_mfma_f32_16x16x32_bf16 v[100:103], v[68:71], v[140:143], v[100:103]
    ds_read_b64_tr_b16 v[54:55], v31 offset:18432
    v_lshl_add_u32 v115, v36, 5, v115
    s_waitcnt lgkmcnt(10)
    s_waitcnt vmcnt(6)
    s_barrier
    buffer_store_dword v39, v38, s[28:31], s5 offen offset:0 sc1
    v_mfma_f32_16x16x32_bf16 v[72:75], v[240:243], v[144:147], v[72:75]
    ds_write_b128 v112, v[232:235] offset:49152
    ds_read_b64_tr_b16 v[56:57], v22 offset:32768
    v_lshrrev_b32 v36, 5, v1
    v_mfma_f32_16x16x32_bf16 v[76:79], v[244:247], v[144:147], v[76:79]
    ds_read_b64_tr_b16 v[58:59], v22 offset:34816
    s_add_u32 m0, s41, 65536
    s_mul_i32 s52, s101, s0
    buffer_load_dwordx4 v7, s[20:23], s52 offen lds
    v_mfma_f32_16x16x32_bf16 v[80:83], v[248:251], v[144:147], v[80:83]
    ds_write_b128 v112, v[236:239] offset:57344
    ds_read_b64_tr_b16 v[60:61], v25 offset:32768
    v_lshl_add_u32 v115, v36, 4, v115
    v_mfma_f32_16x16x32_bf16 v[84:87], v[252:255], v[144:147], v[84:87]
    ds_read_b64_tr_b16 v[62:63], v25 offset:34816
    v_mfma_f32_16x16x32_bf16 v[88:91], v[240:243], v[148:151], v[88:91]
    ds_read_b64_tr_b16 v[64:65], v28 offset:32768
    s_add_u32 m0, s41, 73728
    s_nop 0
    buffer_load_dwordx4 v37, s[20:23], s52 offen lds
    v_mfma_f32_16x16x32_bf16 v[92:95], v[244:247], v[148:151], v[92:95]
    ds_read_b64_tr_b16 v[66:67], v28 offset:34816
    v_mfma_f32_16x16x32_bf16 v[96:99], v[248:251], v[148:151], v[96:99]
    ds_read_b64_tr_b16 v[68:69], v31 offset:32768
    buffer_load_dwordx4 v[192:195], v0, s[28:31], s83 offen sc1
    v_mfma_f32_16x16x32_bf16 v[100:103], v[252:255], v[148:151], v[100:103]
    ds_read_b64_tr_b16 v[70:71], v31 offset:34816
    s_waitcnt lgkmcnt(10)
    v_mfma_f32_16x16x32_bf16 v[72:75], v[40:43], v[152:155], v[72:75]
    ds_read_b64_tr_b16 v[240:241], v21 offset:16384
    v_mfma_f32_16x16x32_bf16 v[76:79], v[44:47], v[152:155], v[76:79]
    ds_read_b64_tr_b16 v[242:243], v21 offset:18432
    buffer_load_dwordx4 v[196:199], v13, s[28:31], s83 offen sc1
    v_mfma_f32_16x16x32_bf16 v[80:83], v[48:51], v[152:155], v[80:83]
    ds_read_b64_tr_b16 v[244:245], v24 offset:16384
    v_mfma_f32_16x16x32_bf16 v[84:87], v[52:55], v[152:155], v[84:87]
    ds_read_b64_tr_b16 v[246:247], v24 offset:18432
    v_mfma_f32_16x16x32_bf16 v[88:91], v[40:43], v[156:159], v[88:91]
    ds_read_b64_tr_b16 v[248:249], v27 offset:16384
    buffer_load_dwordx4 v[200:203], v0, s[28:31], s100 offen sc1
    v_mfma_f32_16x16x32_bf16 v[92:95], v[44:47], v[156:159], v[92:95]
    ds_read_b64_tr_b16 v[250:251], v27 offset:18432
    v_mfma_f32_16x16x32_bf16 v[96:99], v[48:51], v[156:159], v[96:99]
    ds_read_b64_tr_b16 v[252:253], v30 offset:16384
    buffer_load_dwordx4 v[204:207], v13, s[28:31], s100 offen sc1
    v_mfma_f32_16x16x32_bf16 v[100:103], v[52:55], v[156:159], v[100:103]
    ds_read_b64_tr_b16 v[254:255], v30 offset:18432
    s_waitcnt lgkmcnt(8)
    s_barrier
    v_mfma_f32_16x16x32_bf16 v[72:75], v[56:59], v[160:163], v[72:75]
    ds_read_b64_tr_b16 v[40:41], v21 offset:0
    v_mfma_f32_16x16x32_bf16 v[76:79], v[60:63], v[160:163], v[76:79]
    ds_read_b64_tr_b16 v[42:43], v21 offset:2048
    s_add_u32 m0, s41, 81920
    s_mul_i32 s52, s7, s0
    buffer_load_dwordx4 v7, s[20:23], s52 offen lds
    v_mfma_f32_16x16x32_bf16 v[80:83], v[64:67], v[160:163], v[80:83]
    ds_read_b64_tr_b16 v[44:45], v24 offset:0
    s_lshl_b32 s54, s41, 1
    v_mfma_f32_16x16x32_bf16 v[84:87], v[68:71], v[160:163], v[84:87]
    ds_read_b64_tr_b16 v[46:47], v24 offset:2048
    s_add_u32 s54, s54, 65536
    v_mfma_f32_16x16x32_bf16 v[88:91], v[56:59], v[164:167], v[88:91]
    ds_read_b64_tr_b16 v[48:49], v27 offset:0
    s_add_u32 m0, s41, 90112
    s_nop 0
    buffer_load_dwordx4 v37, s[20:23], s52 offen lds
    v_mfma_f32_16x16x32_bf16 v[92:95], v[60:63], v[164:167], v[92:95]
    ds_read_b64_tr_b16 v[50:51], v27 offset:2048
    v_mfma_f32_16x16x32_bf16 v[96:99], v[64:67], v[164:167], v[96:99]
    ds_read_b64_tr_b16 v[52:53], v30 offset:0
    s_add_u32 m0, s41, 98304
    s_mul_i32 s52, s86, s0
    buffer_load_dwordx4 v7, s[20:23], s52 offen lds
    v_mfma_f32_16x16x32_bf16 v[100:103], v[68:71], v[164:167], v[100:103]
    ds_read_b64_tr_b16 v[54:55], v30 offset:2048
    s_waitcnt lgkmcnt(8)
    s_mov_b64 exec, 0xffff
    buffer_load_dword v107, v104, s[28:31], s85 offen sc1
    s_mov_b64 exec, -1
    s_mov_b64 exec, 0x1c000000
    buffer_load_dword v108, v12, s[28:31], s85 offen sc1
    s_mov_b64 exec, -1
    s_waitcnt vmcnt(17)
    v_mfma_f32_16x16x32_bf16 v[72:75], v[240:243], v[168:171], v[72:75]
    ds_read_b64_tr_b16 v[56:57], v22 offset:49152
    v_mfma_f32_16x16x32_bf16 v[76:79], v[244:247], v[168:171], v[76:79]
    ds_read_b64_tr_b16 v[58:59], v22 offset:51200
    s_add_u32 m0, s41, 106496
    s_nop 0
    buffer_load_dwordx4 v37, s[20:23], s52 offen lds
    v_mfma_f32_16x16x32_bf16 v[80:83], v[248:251], v[168:171], v[80:83]
    ds_read_b64_tr_b16 v[60:61], v25 offset:49152
    v_add_u32 v117, s54, v2
    v_mfma_f32_16x16x32_bf16 v[84:87], v[252:255], v[168:171], v[84:87]
    ds_read_b64_tr_b16 v[62:63], v25 offset:51200
    v_xor_b32 v118, 4096, v117
    s_waitcnt vmcnt(17)
    v_mfma_f32_16x16x32_bf16 v[88:91], v[240:243], v[172:175], v[88:91]
    ds_read_b64_tr_b16 v[64:65], v28 offset:49152
    buffer_load_dwordx4 v[208:211], v0, s[28:31], s101 offen sc1
    v_mfma_f32_16x16x32_bf16 v[92:95], v[244:247], v[172:175], v[92:95]
    ds_read_b64_tr_b16 v[66:67], v28 offset:51200
    v_mfma_f32_16x16x32_bf16 v[96:99], v[248:251], v[172:175], v[96:99]
    ds_read_b64_tr_b16 v[68:69], v31 offset:49152
    buffer_load_dwordx4 v[212:215], v13, s[28:31], s101 offen sc1
    v_mfma_f32_16x16x32_bf16 v[100:103], v[252:255], v[172:175], v[100:103]
    ds_read_b64_tr_b16 v[70:71], v31 offset:51200
    s_waitcnt lgkmcnt(8)
    s_barrier
    s_waitcnt vmcnt(18)
    v_mfma_f32_16x16x32_bf16 v[72:75], v[40:43], v[176:179], v[72:75]
    ds_read_b64_tr_b16 v[240:241], v21 offset:32768
    v_mfma_f32_16x16x32_bf16 v[76:79], v[44:47], v[176:179], v[76:79]
    ds_read_b64_tr_b16 v[242:243], v21 offset:34816
    s_add_u32 m0, s41, 0
    s_mul_i32 s52, s97, 49
    s_lshr_b32 s52, s52, 1
    buffer_load_dwordx4 v15, s[24:27], s52 offen lds
    v_mfma_f32_16x16x32_bf16 v[80:83], v[48:51], v[176:179], v[80:83]
    ds_read_b64_tr_b16 v[244:245], v24 offset:32768
    v_xor_b32 v119, 8192, v117
    v_mfma_f32_16x16x32_bf16 v[84:87], v[52:55], v[176:179], v[84:87]
    ds_read_b64_tr_b16 v[246:247], v24 offset:34816
    v_xor_b32 v116, 12288, v117
    s_waitcnt vmcnt(18)
    v_mfma_f32_16x16x32_bf16 v[88:91], v[40:43], v[180:183], v[88:91]
    ds_read_b64_tr_b16 v[248:249], v27 offset:32768
    s_add_u32 m0, s41, 8192
    s_nop 0
    buffer_load_dwordx4 v16, s[24:27], s52 offen lds
    v_mfma_f32_16x16x32_bf16 v[92:95], v[44:47], v[180:183], v[92:95]
    ds_read_b64_tr_b16 v[250:251], v27 offset:34816
    v_mfma_f32_16x16x32_bf16 v[96:99], v[48:51], v[180:183], v[96:99]
    ds_read_b64_tr_b16 v[252:253], v30 offset:32768
    buffer_load_dwordx4 v[216:219], v0, s[28:31], s7 offen sc1
    v_mfma_f32_16x16x32_bf16 v[100:103], v[52:55], v[180:183], v[100:103]
    ds_read_b64_tr_b16 v[254:255], v30 offset:34816
    s_waitcnt lgkmcnt(8)
    s_waitcnt vmcnt(19)
    v_mfma_f32_16x16x32_bf16 v[72:75], v[56:59], v[184:187], v[72:75]
    ds_read_b64_tr_b16 v[40:41], v23 offset:0
    v_mfma_f32_16x16x32_bf16 v[76:79], v[60:63], v[184:187], v[76:79]
    ds_read_b64_tr_b16 v[42:43], v23 offset:2048
    s_add_u32 m0, s41, 16384
    s_mul_i32 s52, s90, 49
    s_lshr_b32 s52, s52, 1
    buffer_load_dwordx4 v15, s[24:27], s52 offen lds
    v_mfma_f32_16x16x32_bf16 v[80:83], v[64:67], v[184:187], v[80:83]
    ds_read_b64_tr_b16 v[44:45], v26 offset:0
    v_mfma_f32_16x16x32_bf16 v[84:87], v[68:71], v[184:187], v[84:87]
    ds_read_b64_tr_b16 v[46:47], v26 offset:2048
    s_waitcnt vmcnt(19)
    v_mfma_f32_16x16x32_bf16 v[88:91], v[56:59], v[188:191], v[88:91]
    ds_read_b64_tr_b16 v[48:49], v29 offset:0
    buffer_load_dwordx4 v[220:223], v13, s[28:31], s7 offen sc1
    v_mfma_f32_16x16x32_bf16 v[92:95], v[60:63], v[188:191], v[92:95]
    ds_read_b64_tr_b16 v[50:51], v29 offset:2048
    v_mfma_f32_16x16x32_bf16 v[96:99], v[64:67], v[188:191], v[96:99]
    ds_read_b64_tr_b16 v[52:53], v32 offset:0
    s_add_u32 m0, s41, 24576
    s_nop 0
    buffer_load_dwordx4 v16, s[24:27], s52 offen lds
    v_mfma_f32_16x16x32_bf16 v[100:103], v[68:71], v[188:191], v[100:103]
    ds_read_b64_tr_b16 v[54:55], v32 offset:2048
    s_waitcnt lgkmcnt(8)
    s_and_b32 s56, s84, 0xffff
    s_waitcnt vmcnt(10)
    v_cmp_ne_u32 vcc, s53, v107
    s_nop 0
    s_and_b32 s55, vcc_lo, s56
    s_cbranch_scc1 L_po_slow
L_po_back:
    s_and_b32 s56, s84, 0x1c000000
    s_waitcnt vmcnt(9)
    v_cmp_ne_u32 vcc, s53, v108
    s_nop 0
    s_and_b32 s55, vcc_lo, s56
    s_cbranch_scc1 L_pt_slow
L_pt_back:
    s_barrier
    v_mfma_f32_16x16x32_bf16 v[72:75], v[240:243], v[192:195], v[72:75]
    ds_read_b64_tr_b16 v[56:57], v22 offset:0
    v_mfma_f32_16x16x32_bf16 v[76:79], v[244:247], v[192:195], v[76:79]
    ds_read_b64_tr_b16 v[58:59], v22 offset:2048
    buffer_load_dwordx4 v[224:227], v0, s[28:31], s86 offen sc1
    v_mfma_f32_16x16x32_bf16 v[80:83], v[248:251], v[192:195], v[80:83]
    ds_read_b64_tr_b16 v[60:61], v25 offset:0
    v_mfma_f32_16x16x32_bf16 v[84:87], v[252:255], v[192:195], v[84:87]
    ds_read_b64_tr_b16 v[62:63], v25 offset:2048
    v_mfma_f32_16x16x32_bf16 v[88:91], v[240:243], v[196:199], v[88:91]
    ds_read_b64_tr_b16 v[64:65], v28 offset:0
    s_add_u32 m0, s41, 32768
    s_mul_i32 s52, s44, 49
    s_lshr_b32 s52, s52, 1
    buffer_load_dwordx4 v15, s[24:27], s52 offen lds
    v_mfma_f32_16x16x32_bf16 v[92:95], v[244:247], v[196:199], v[92:95]
    ds_read_b64_tr_b16 v[66:67], v28 offset:2048
    v_mfma_f32_16x16x32_bf16 v[96:99], v[248:251], v[196:199], v[96:99]
    ds_read_b64_tr_b16 v[68:69], v31 offset:0
    buffer_load_dwordx4 v[228:231], v13, s[28:31], s86 offen sc1
    v_mfma_f32_16x16x32_bf16 v[100:103], v[252:255], v[196:199], v[100:103]
    ds_read_b64_tr_b16 v[70:71], v31 offset:2048
    s_waitcnt lgkmcnt(8)
    v_mfma_f32_16x16x32_bf16 v[72:75], v[40:43], v[200:203], v[72:75]
    ds_read_b64_tr_b16 v[240:241], v22 offset:16384
    v_mfma_f32_16x16x32_bf16 v[76:79], v[44:47], v[200:203], v[76:79]
    ds_read_b64_tr_b16 v[242:243], v22 offset:18432
    s_add_u32 m0, s41, 40960
    s_nop 0
    buffer_load_dwordx4 v16, s[24:27], s52 offen lds
    v_mfma_f32_16x16x32_bf16 v[80:83], v[48:51], v[200:203], v[80:83]
    ds_read_b64_tr_b16 v[244:245], v25 offset:16384
    v_mfma_f32_16x16x32_bf16 v[84:87], v[52:55], v[200:203], v[84:87]
    ds_read_b64_tr_b16 v[246:247], v25 offset:18432
    v_mfma_f32_16x16x32_bf16 v[88:91], v[40:43], v[204:207], v[88:91]
    ds_read_b64_tr_b16 v[248:249], v28 offset:16384
    s_mov_b32 s57, 53248
    buffer_load_dwordx4 v[232:235], v0, s[28:31], s57 offen sc1
    v_mfma_f32_16x16x32_bf16 v[92:95], v[44:47], v[204:207], v[92:95]
    ds_read_b64_tr_b16 v[250:251], v28 offset:18432
    v_mfma_f32_16x16x32_bf16 v[96:99], v[48:51], v[204:207], v[96:99]
    ds_read_b64_tr_b16 v[252:253], v31 offset:16384
    s_mov_b32 s57, 53248
    buffer_load_dwordx4 v[236:239], v13, s[28:31], s57 offen sc1
    v_mfma_f32_16x16x32_bf16 v[100:103], v[52:55], v[204:207], v[100:103]
    ds_read_b64_tr_b16 v[254:255], v31 offset:18432
    s_waitcnt lgkmcnt(8)
    s_waitcnt vmcnt(14)
    s_barrier
    s_waitcnt vmcnt(13)
    v_mfma_f32_16x16x32_bf16 v[72:75], v[56:59], v[208:211], v[72:75]
    ds_read_b64_tr_b16 v[40:41], v22 offset:32768
    v_mfma_f32_16x16x32_bf16 v[76:79], v[60:63], v[208:211], v[76:79]
    ds_read_b64_tr_b16 v[42:43], v22 offset:34816
    buffer_load_dword v105, v114, s[28:31], s6 offen sc1
    v_mfma_f32_16x16x32_bf16 v[80:83], v[64:67], v[208:211], v[80:83]
    ds_read_b64_tr_b16 v[44:45], v25 offset:32768
    v_mfma_f32_16x16x32_bf16 v[84:87], v[68:71], v[208:211], v[84:87]
    ds_read_b64_tr_b16 v[46:47], v25 offset:34816
    s_waitcnt vmcnt(13)
    v_mfma_f32_16x16x32_bf16 v[88:91], v[56:59], v[212:215], v[88:91]
    ds_read_b64_tr_b16 v[48:49], v28 offset:32768
    s_xor_b32 s57, s6, 64
    buffer_load_dword v106, v114, s[28:31], s57 offen sc1
    v_mfma_f32_16x16x32_bf16 v[92:95], v[60:63], v[212:215], v[92:95]
    ds_read_b64_tr_b16 v[50:51], v28 offset:34816
    v_mfma_f32_16x16x32_bf16 v[96:99], v[64:67], v[212:215], v[96:99]
    ds_read_b64_tr_b16 v[52:53], v31 offset:32768
    buffer_load_dwordx4 v[128:131], v17, s[28:31], s93 offen sc1
    v_mfma_f32_16x16x32_bf16 v[100:103], v[68:71], v[212:215], v[100:103]
    ds_read_b64_tr_b16 v[54:55], v31 offset:34816
    s_waitcnt lgkmcnt(8)
    s_waitcnt vmcnt(12)
    v_mfma_f32_16x16x32_bf16 v[72:75], v[240:243], v[216:219], v[72:75]
    ds_read_b64_tr_b16 v[56:57], v23 offset:16384
    v_mfma_f32_16x16x32_bf16 v[76:79], v[244:247], v[216:219], v[76:79]
    ds_read_b64_tr_b16 v[58:59], v23 offset:18432
    buffer_load_dwordx4 v[132:135], v18, s[28:31], s93 offen sc1
    v_mfma_f32_16x16x32_bf16 v[80:83], v[248:251], v[216:219], v[80:83]
    ds_read_b64_tr_b16 v[60:61], v26 offset:16384
    v_mfma_f32_16x16x32_bf16 v[84:87], v[252:255], v[216:219], v[84:87]
    ds_read_b64_tr_b16 v[62:63], v26 offset:18432
    s_waitcnt vmcnt(11)
    v_mfma_f32_16x16x32_bf16 v[88:91], v[240:243], v[220:223], v[88:91]
    ds_read_b64_tr_b16 v[64:65], v29 offset:16384
    buffer_load_dwordx4 v[136:139], v17, s[28:31], s97 offen sc1
    v_mfma_f32_16x16x32_bf16 v[92:95], v[244:247], v[220:223], v[92:95]
    ds_read_b64_tr_b16 v[66:67], v29 offset:18432
    v_mfma_f32_16x16x32_bf16 v[96:99], v[248:251], v[220:223], v[96:99]
    ds_read_b64_tr_b16 v[68:69], v32 offset:16384
    buffer_load_dwordx4 v[140:143], v18, s[28:31], s97 offen sc1
    v_mfma_f32_16x16x32_bf16 v[100:103], v[252:255], v[220:223], v[100:103]
    ds_read_b64_tr_b16 v[70:71], v32 offset:18432
    s_waitcnt lgkmcnt(8)
    s_barrier
    s_waitcnt vmcnt(11)
    v_mfma_f32_16x16x32_bf16 v[72:75], v[40:43], v[224:227], v[72:75]
    ds_read_b64_tr_b16 v[240:241], v21 offset:49152
    v_mfma_f32_16x16x32_bf16 v[76:79], v[44:47], v[224:227], v[76:79]
    ds_read_b64_tr_b16 v[242:243], v21 offset:51200
    buffer_load_dwordx4 v[144:147], v17, s[28:31], s90 offen sc1
    v_mfma_f32_16x16x32_bf16 v[80:83], v[48:51], v[224:227], v[80:83]
    ds_read_b64_tr_b16 v[244:245], v24 offset:49152
    v_mfma_f32_16x16x32_bf16 v[84:87], v[52:55], v[224:227], v[84:87]
    ds_read_b64_tr_b16 v[246:247], v24 offset:51200
    s_waitcnt vmcnt(10)
    v_mfma_f32_16x16x32_bf16 v[88:91], v[40:43], v[228:231], v[88:91]
    ds_read_b64_tr_b16 v[248:249], v27 offset:49152
    buffer_load_dwordx4 v[148:151], v18, s[28:31], s90 offen sc1
    v_mfma_f32_16x16x32_bf16 v[92:95], v[44:47], v[228:231], v[92:95]
    ds_read_b64_tr_b16 v[250:251], v27 offset:51200
    v_mfma_f32_16x16x32_bf16 v[96:99], v[48:51], v[228:231], v[96:99]
    ds_read_b64_tr_b16 v[252:253], v30 offset:49152
    buffer_load_dwordx4 v[152:155], v17, s[28:31], s44 offen sc1
    v_mfma_f32_16x16x32_bf16 v[100:103], v[52:55], v[228:231], v[100:103]
    ds_read_b64_tr_b16 v[254:255], v30 offset:51200
    s_waitcnt lgkmcnt(8)
    s_waitcnt vmcnt(10)
    v_mfma_f32_16x16x32_bf16 v[72:75], v[56:59], v[232:235], v[72:75]
    ds_read_b64_tr_b16 v[40:41], v21 offset:0
    v_mfma_f32_16x16x32_bf16 v[76:79], v[60:63], v[232:235], v[76:79]
    ds_read_b64_tr_b16 v[42:43], v21 offset:2048
    buffer_load_dwordx4 v[156:159], v18, s[28:31], s44 offen sc1
    v_mfma_f32_16x16x32_bf16 v[80:83], v[64:67], v[232:235], v[80:83]
    ds_read_b64_tr_b16 v[44:45], v24 offset:0
    v_mfma_f32_16x16x32_bf16 v[84:87], v[68:71], v[232:235], v[84:87]
    ds_read_b64_tr_b16 v[46:47], v24 offset:2048
    s_waitcnt vmcnt(10)
    v_mfma_f32_16x16x32_bf16 v[88:91], v[56:59], v[236:239], v[88:91]
    ds_read_b64_tr_b16 v[48:49], v27 offset:0
    v_mfma_f32_16x16x32_bf16 v[92:95], v[60:63], v[236:239], v[92:95]
    ds_read_b64_tr_b16 v[50:51], v27 offset:2048
    v_mfma_f32_16x16x32_bf16 v[96:99], v[64:67], v[236:239], v[96:99]
    ds_read_b64_tr_b16 v[52:53], v30 offset:0
    v_mfma_f32_16x16x32_bf16 v[100:103], v[68:71], v[236:239], v[100:103]
    ds_read_b64_tr_b16 v[54:55], v30 offset:2048
    s_waitcnt lgkmcnt(8)
    s_barrier
    s_waitcnt vmcnt(8)
    s_waitcnt vmcnt(7)
    v_mfma_f32_16x16x32_bf16 v[160:163], v[240:243], v[128:131], 0
    ds_read_b64_tr_b16 v[56:57], v21 offset:16384
    v_sub_f32 v110, 1.0, v105
    v_mfma_f32_16x16x32_bf16 v[164:167], v[244:247], v[128:131], 0
    ds_read_b64_tr_b16 v[58:59], v21 offset:18432
    v_cvt_pk_bf16_f32 v110, v110, v110
    v_mfma_f32_16x16x32_bf16 v[168:171], v[248:251], v[128:131], 0
    ds_read_b64_tr_b16 v[60:61], v24 offset:16384
    v_lshlrev_b32 v110, 16, v110
    v_mfma_f32_16x16x32_bf16 v[172:175], v[252:255], v[128:131], 0
    ds_read_b64_tr_b16 v[62:63], v24 offset:18432
    v_sub_f32 v111, 1.0, v106
    s_waitcnt vmcnt(6)
    v_mfma_f32_16x16x32_bf16 v[176:179], v[240:243], v[132:135], 0
    ds_read_b64_tr_b16 v[64:65], v27 offset:16384
    v_cvt_pk_bf16_f32 v111, v111, v111
    v_mfma_f32_16x16x32_bf16 v[180:183], v[244:247], v[132:135], 0
    ds_read_b64_tr_b16 v[66:67], v27 offset:18432
    v_lshlrev_b32 v111, 16, v111
    v_mfma_f32_16x16x32_bf16 v[184:187], v[248:251], v[132:135], 0
    ds_read_b64_tr_b16 v[68:69], v30 offset:16384
    v_mul_f32 v72, v72, v110
    v_mfma_f32_16x16x32_bf16 v[188:191], v[252:255], v[132:135], 0
    ds_read_b64_tr_b16 v[70:71], v30 offset:18432
    v_mul_f32 v73, v73, v110
    s_waitcnt lgkmcnt(8)
    s_waitcnt vmcnt(5)
    v_mfma_f32_16x16x32_bf16 v[160:163], v[40:43], v[136:139], v[160:163]
    ds_read_b64_tr_b16 v[240:241], v21 offset:32768
    v_mul_f32 v74, v74, v110
    v_mfma_f32_16x16x32_bf16 v[164:167], v[44:47], v[136:139], v[164:167]
    ds_read_b64_tr_b16 v[242:243], v21 offset:34816
    v_mul_f32 v75, v75, v110
    v_mfma_f32_16x16x32_bf16 v[168:171], v[48:51], v[136:139], v[168:171]
    ds_read_b64_tr_b16 v[244:245], v24 offset:32768
    v_mul_f32 v76, v76, v110
    v_mfma_f32_16x16x32_bf16 v[172:175], v[52:55], v[136:139], v[172:175]
    ds_read_b64_tr_b16 v[246:247], v24 offset:34816
    v_mul_f32 v77, v77, v110
    s_waitcnt vmcnt(4)
    v_mfma_f32_16x16x32_bf16 v[176:179], v[40:43], v[140:143], v[176:179]
    ds_read_b64_tr_b16 v[248:249], v27 offset:32768
    v_mul_f32 v78, v78, v110
    v_mfma_f32_16x16x32_bf16 v[180:183], v[44:47], v[140:143], v[180:183]
    ds_read_b64_tr_b16 v[250:251], v27 offset:34816
    v_mul_f32 v79, v79, v110
    v_mfma_f32_16x16x32_bf16 v[184:187], v[48:51], v[140:143], v[184:187]
    ds_read_b64_tr_b16 v[252:253], v30 offset:32768
    v_mul_f32 v80, v80, v110
    v_mfma_f32_16x16x32_bf16 v[188:191], v[52:55], v[140:143], v[188:191]
    ds_read_b64_tr_b16 v[254:255], v30 offset:34816
    v_mul_f32 v81, v81, v110
    s_waitcnt lgkmcnt(8)
    s_waitcnt vmcnt(3)
    v_mfma_f32_16x16x32_bf16 v[160:163], v[56:59], v[144:147], v[160:163]
    v_mul_f32 v82, v82, v110
    v_mul_f32 v83, v83, v110
    v_mul_f32 v84, v84, v110
    v_mfma_f32_16x16x32_bf16 v[164:167], v[60:63], v[144:147], v[164:167]
    v_mul_f32 v85, v85, v110
    v_mul_f32 v86, v86, v110
    v_mul_f32 v87, v87, v110
    v_mfma_f32_16x16x32_bf16 v[168:171], v[64:67], v[144:147], v[168:171]
    v_mul_f32 v88, v88, v111
    v_mul_f32 v89, v89, v111
    v_mul_f32 v90, v90, v111
    v_mfma_f32_16x16x32_bf16 v[172:175], v[68:71], v[144:147], v[172:175]
    v_mul_f32 v91, v91, v111
    v_mul_f32 v92, v92, v111
    v_mul_f32 v93, v93, v111
    s_waitcnt vmcnt(2)
    v_mfma_f32_16x16x32_bf16 v[176:179], v[56:59], v[148:151], v[176:179]
    v_mul_f32 v94, v94, v111
    v_mul_f32 v95, v95, v111
    v_mul_f32 v96, v96, v111
    v_mfma_f32_16x16x32_bf16 v[180:183], v[60:63], v[148:151], v[180:183]
    v_mul_f32 v97, v97, v111
    v_mul_f32 v98, v98, v111
    v_mul_f32 v99, v99, v111
    v_mfma_f32_16x16x32_bf16 v[184:187], v[64:67], v[148:151], v[184:187]
    v_mul_f32 v100, v100, v111
    v_mul_f32 v101, v101, v111
    v_mul_f32 v102, v102, v111
    v_mfma_f32_16x16x32_bf16 v[188:191], v[68:71], v[148:151], v[188:191]
    v_mul_f32 v103, v103, v111
    s_waitcnt lgkmcnt(0)
    s_waitcnt vmcnt(0)
    v_mfma_f32_16x16x32_bf16 v[176:179], v[240:243], v[156:159], v[176:179]
    v_mfma_f32_16x16x32_bf16 v[180:183], v[244:247], v[156:159], v[180:183]
    v_mfma_f32_16x16x32_bf16 v[184:187], v[248:251], v[156:159], v[184:187]
    v_mfma_f32_16x16x32_bf16 v[188:191], v[252:255], v[156:159], v[188:191]
    s_nop 4
    v_fma_f32 v88, v176, v106, v88
    v_fma_f32 v89, v177, v106, v89
    v_fma_f32 v90, v178, v106, v90
    v_fma_f32 v91, v179, v106, v91
    ds_write_b128 v117, v[88:91] offset:0
    v_mfma_f32_16x16x32_bf16 v[168:171], v[248:251], v[152:155], v[168:171]
    v_fma_f32 v92, v180, v106, v92
    v_fma_f32 v93, v181, v106, v93
    v_fma_f32 v94, v182, v106, v94
    v_fma_f32 v95, v183, v106, v95
    ds_write_b128 v117, v[92:95] offset:1024
    v_mfma_f32_16x16x32_bf16 v[172:175], v[252:255], v[152:155], v[172:175]
    v_fma_f32 v96, v184, v106, v96
    v_fma_f32 v97, v185, v106, v97
    v_fma_f32 v98, v186, v106, v98
    v_fma_f32 v99, v187, v106, v99
    ds_write_b128 v117, v[96:99] offset:32768
    v_mfma_f32_16x16x32_bf16 v[160:163], v[240:243], v[152:155], v[160:163]
    v_fma_f32 v100, v188, v106, v100
    v_fma_f32 v101, v189, v106, v101
    v_fma_f32 v102, v190, v106, v102
    v_fma_f32 v103, v191, v106, v103
    ds_write_b128 v117, v[100:103] offset:33792
    v_mfma_f32_16x16x32_bf16 v[164:167], v[244:247], v[152:155], v[164:167]
    v_fma_f32 v80, v168, v105, v80
    v_fma_f32 v81, v169, v105, v81
    v_fma_f32 v82, v170, v105, v82
    v_fma_f32 v83, v171, v105, v83
    ds_write_b128 v117, v[80:83] offset:16384
    v_fma_f32 v84, v172, v105, v84
    v_fma_f32 v85, v173, v105, v85
    v_fma_f32 v86, v174, v105, v86
    v_fma_f32 v87, v175, v105, v87
    ds_write_b128 v117, v[84:87] offset:17408
    s_waitcnt lgkmcnt(0)
    s_barrier
    ds_read_b128 v[44:47], v118 offset:0
    ds_read_b128 v[48:51], v118 offset:1024
    ds_read_b128 v[52:55], v119 offset:16384
    ds_read_b128 v[56:59], v119 offset:17408
    ds_read_b128 v[60:63], v116 offset:32768
    ds_read_b128 v[64:67], v116 offset:33792
    v_fma_f32 v72, v160, v105, v72
    v_fma_f32 v73, v161, v105, v73
    v_fma_f32 v74, v162, v105, v74
    v_fma_f32 v75, v163, v105, v75
    v_fma_f32 v76, v164, v105, v76
    v_fma_f32 v77, v165, v105, v77
    v_fma_f32 v78, v166, v105, v78
    v_fma_f32 v79, v167, v105, v79
    s_waitcnt lgkmcnt(4)
    v_add_f32 v72, v72, v44
    v_add_f32 v73, v73, v45
    v_add_f32 v74, v74, v46
    v_add_f32 v75, v75, v47
    v_add_f32 v76, v76, v48
    v_add_f32 v77, v77, v49
    v_add_f32 v78, v78, v50
    v_add_f32 v79, v79, v51
    s_waitcnt lgkmcnt(2)
    v_add_f32 v72, v72, v52
    v_add_f32 v73, v73, v53
    v_add_f32 v74, v74, v54
    v_add_f32 v75, v75, v55
    v_add_f32 v76, v76, v56
    v_add_f32 v77, v77, v57
    v_add_f32 v78, v78, v58
    v_add_f32 v79, v79, v59
    s_waitcnt lgkmcnt(0)
    v_add_f32 v72, v72, v60
    v_add_f32 v73, v73, v61
    v_add_f32 v74, v74, v62
    v_add_f32 v75, v75, v63
    v_add_f32 v76, v76, v64
    v_add_f32 v77, v77, v65
    v_add_f32 v78, v78, v66
    v_add_f32 v79, v79, v67
    v_cvt_pk_bf16_f32 v44, v72, v73
    v_cvt_pk_bf16_f32 v45, v74, v75
    v_cvt_pk_bf16_f32 v46, v76, v77
    v_cvt_pk_bf16_f32 v47, v78, v79
    s_nop 0
    v_permlane16_swap_b32 v44, v46
    v_permlane16_swap_b32 v45, v47
    buffer_store_dwordx4 v[44:47], v115, s[32:35], s89 offen nt
L_fin:
L_end:
    s_endpgm
L_helper:
    s_waitcnt lgkmcnt(0)
    s_barrier
    ds_read_b128 v[108:111], v4 offset:0
    ds_read_b128 v[112:115], v4 offset:1024
    ds_read_b128 v[116:119], v4 offset:2048
    s_waitcnt lgkmcnt(2)
    v_mfma_f32_16x16x32_bf16 v[40:43], v[108:111], v[248:251], v[240:243]
    ds_read_b128 v[108:111], v4 offset:3072
    s_waitcnt lgkmcnt(2)
    v_mfma_f32_16x16x32_bf16 v[44:47], v[112:115], v[248:251], 0
    ds_read_b128 v[112:115], v4 offset:4096
    s_mov_b64 exec, 0x3f00
    buffer_load_dword v5, v14, s[28:31], s85 offen sc1
    s_mov_b64 exec, -1
    s_waitcnt lgkmcnt(2)
    v_mfma_f32_16x16x32_bf16 v[48:51], v[116:119], v[248:251], 0
    ds_read_b128 v[116:119], v4 offset:5120
    s_waitcnt lgkmcnt(2)
    v_mfma_f32_16x16x32_bf16 v[52:55], v[108:111], v[248:251], 0
    ds_read_b128 v[108:111], v4 offset:6144
    v_max3_f32 v35, v40, v41, v42
    v_max_f32 v35, v35, v43
    s_waitcnt lgkmcnt(2)
    v_mfma_f32_16x16x32_bf16 v[56:59], v[112:115], v[248:251], 0
    ds_read_b128 v[112:115], v4 offset:7168
    v_max3_f32 v35, v35, v44, v45
    v_max3_f32 v35, v35, v46, v47
    s_waitcnt lgkmcnt(2)
    v_mfma_f32_16x16x32_bf16 v[60:63], v[116:119], v[248:251], 0
    ds_read_b128 v[116:119], v4 offset:8192
    v_max3_f32 v35, v35, v48, v49
    v_max3_f32 v35, v35, v50, v51
    s_waitcnt lgkmcnt(2)
    v_mfma_f32_16x16x32_bf16 v[64:67], v[108:111], v[248:251], 0
    ds_read_b128 v[108:111], v4 offset:9216
    v_max3_f32 v35, v35, v52, v53
    v_max3_f32 v35, v35, v54, v55
    s_waitcnt lgkmcnt(2)
    v_mfma_f32_16x16x32_bf16 v[68:71], v[112:115], v[248:251], 0
    ds_read_b128 v[112:115], v4 offset:10240
    v_max3_f32 v35, v35, v56, v57
    v_max3_f32 v35, v35, v58, v59
    s_waitcnt lgkmcnt(2)
    v_mfma_f32_16x16x32_bf16 v[72:75], v[116:119], v[248:251], 0
    ds_read_b128 v[116:119], v4 offset:11264
    v_max3_f32 v35, v35, v60, v61
    v_max3_f32 v35, v35, v62, v63
    s_waitcnt lgkmcnt(2)
    v_mfma_f32_16x16x32_bf16 v[76:79], v[108:111], v[248:251], 0
    ds_read_b128 v[108:111], v4 offset:12288
    v_max3_f32 v35, v35, v64, v65
    v_max3_f32 v35, v35, v66, v67
    s_waitcnt lgkmcnt(2)
    v_mfma_f32_16x16x32_bf16 v[80:83], v[112:115], v[248:251], 0
    ds_read_b128 v[112:115], v4 offset:13312
    v_max3_f32 v35, v35, v68, v69
    v_max3_f32 v35, v35, v70, v71
    s_waitcnt lgkmcnt(2)
    v_mfma_f32_16x16x32_bf16 v[84:87], v[116:119], v[248:251], 0
    ds_read_b128 v[116:119], v4 offset:14336
    v_max3_f32 v35, v35, v72, v73
    v_max3_f32 v35, v35, v74, v75
    s_waitcnt lgkmcnt(2)
    v_mfma_f32_16x16x32_bf16 v[88:91], v[108:111], v[248:251], 0
    ds_read_b128 v[108:111], v4 offset:15360
    v_max3_f32 v35, v35, v76, v77
    v_max3_f32 v35, v35, v78, v79
    s_waitcnt lgkmcnt(2)
    v_mfma_f32_16x16x32_bf16 v[92:95], v[112:115], v[248:251], 0
    ds_read_b128 v[112:115], v4 offset:16384
    v_max3_f32 v35, v35, v80, v81
    v_max3_f32 v35, v35, v82, v83
    s_waitcnt lgkmcnt(2)
    v_mfma_f32_16x16x32_bf16 v[96:99], v[116:119], v[248:251], 0
    v_max3_f32 v35, v35, v84, v85
    v_max3_f32 v35, v35, v86, v87
    s_waitcnt lgkmcnt(1)
    v_mfma_f32_16x16x32_bf16 v[100:103], v[108:111], v[248:251], 0
    v_max3_f32 v35, v35, v88, v89
    v_max3_f32 v35, v35, v90, v91
    s_waitcnt lgkmcnt(0)
    v_mfma_f32_16x16x32_bf16 v[104:107], v[112:115], v[248:251], v[244:247]
    v_max3_f32 v35, v35, v92, v93
    v_max3_f32 v35, v35, v94, v95
    v_max3_f32 v35, v35, v96, v97
    v_max3_f32 v35, v35, v98, v99
    v_max3_f32 v35, v35, v100, v101
    v_max3_f32 v35, v35, v102, v103
    s_nop 1
    v_max3_f32 v35, v35, v104, v105
    v_max3_f32 v35, v35, v106, v107
    v_mov_b32 v33, v35
    s_nop 1
    v_permlane32_swap_b32 v33, v35
    v_max_f32 v35, v35, v33
    v_mov_b32 v33, v35
    s_nop 1
    v_permlane16_swap_b32 v33, v35
    v_max_f32 v35, v35, v33
    v_mul_f32 v36, v35, v8
    v_pk_fma_f32 v[40:41], v[40:41], v[8:9], v[36:37] op_sel_hi:[1,0,0] neg_lo:[0,0,1] neg_hi:[0,0,1]
    v_pk_fma_f32 v[42:43], v[42:43], v[8:9], v[36:37] op_sel_hi:[1,0,0] neg_lo:[0,0,1] neg_hi:[0,0,1]
    v_pk_fma_f32 v[44:45], v[44:45], v[8:9], v[36:37] op_sel_hi:[1,0,0] neg_lo:[0,0,1] neg_hi:[0,0,1]
    v_pk_fma_f32 v[46:47], v[46:47], v[8:9], v[36:37] op_sel_hi:[1,0,0] neg_lo:[0,0,1] neg_hi:[0,0,1]
    v_exp_f32 v40, v40
    v_exp_f32 v41, v41
    v_exp_f32 v42, v42
    v_exp_f32 v43, v43
    v_exp_f32 v44, v44
    v_exp_f32 v45, v45
    v_exp_f32 v46, v46
    v_exp_f32 v47, v47
    v_cvt_pk_bf16_f32 v40, v40, v41
    v_cvt_pk_bf16_f32 v41, v42, v43
    v_cvt_pk_bf16_f32 v42, v44, v45
    v_cvt_pk_bf16_f32 v43, v46, v47
    s_and_b32 s56, s84, 0x3f00
    s_waitcnt vmcnt(0)
    v_cmp_ne_u32 vcc, s53, v5
    s_nop 0
    s_and_b32 s55, vcc_lo, s56
    s_cbranch_scc1 L_pvh_slow
L_pvh_back:
    s_barrier
    s_add_u32 s55, s96, 4096
    buffer_store_dword v39, v38, s[28:31], s55 offen offset:0 sc1
    s_mov_b32 s55, 2113536
    buffer_load_dwordx4 v[252:255], v9, s[28:31], s55 offen sc1
    s_add_u32 s55, s63, 2097152
    buffer_load_dwordx4 v[124:127], v9, s[28:31], s55 offen sc1
    s_add_u32 s55, s3, 2097152
    buffer_load_dwordx4 v[120:123], v9, s[28:31], s55 offen sc1
    v_pk_fma_f32 v[48:49], v[48:49], v[8:9], v[36:37] op_sel_hi:[1,0,0] neg_lo:[0,0,1] neg_hi:[0,0,1]
    v_pk_fma_f32 v[50:51], v[50:51], v[8:9], v[36:37] op_sel_hi:[1,0,0] neg_lo:[0,0,1] neg_hi:[0,0,1]
    v_pk_fma_f32 v[52:53], v[52:53], v[8:9], v[36:37] op_sel_hi:[1,0,0] neg_lo:[0,0,1] neg_hi:[0,0,1]
    v_pk_fma_f32 v[54:55], v[54:55], v[8:9], v[36:37] op_sel_hi:[1,0,0] neg_lo:[0,0,1] neg_hi:[0,0,1]
    v_exp_f32 v48, v48
    v_exp_f32 v49, v49
    v_exp_f32 v50, v50
    v_exp_f32 v51, v51
    v_exp_f32 v52, v52
    v_exp_f32 v53, v53
    v_exp_f32 v54, v54
    v_exp_f32 v55, v55
    v_cvt_pk_bf16_f32 v48, v48, v49
    v_cvt_pk_bf16_f32 v49, v50, v51
    v_cvt_pk_bf16_f32 v50, v52, v53
    v_cvt_pk_bf16_f32 v51, v54, v55
    v_pk_fma_f32 v[56:57], v[56:57], v[8:9], v[36:37] op_sel_hi:[1,0,0] neg_lo:[0,0,1] neg_hi:[0,0,1]
    v_pk_fma_f32 v[58:59], v[58:59], v[8:9], v[36:37] op_sel_hi:[1,0,0] neg_lo:[0,0,1] neg_hi:[0,0,1]
    v_pk_fma_f32 v[60:61], v[60:61], v[8:9], v[36:37] op_sel_hi:[1,0,0] neg_lo:[0,0,1] neg_hi:[0,0,1]
    v_pk_fma_f32 v[62:63], v[62:63], v[8:9], v[36:37] op_sel_hi:[1,0,0] neg_lo:[0,0,1] neg_hi:[0,0,1]
    v_exp_f32 v56, v56
    v_exp_f32 v57, v57
    v_exp_f32 v58, v58
    v_exp_f32 v59, v59
    v_exp_f32 v60, v60
    v_exp_f32 v61, v61
    v_exp_f32 v62, v62
    v_exp_f32 v63, v63
    v_cvt_pk_bf16_f32 v56, v56, v57
    v_cvt_pk_bf16_f32 v57, v58, v59
    v_cvt_pk_bf16_f32 v58, v60, v61
    v_cvt_pk_bf16_f32 v59, v62, v63
    v_pk_fma_f32 v[64:65], v[64:65], v[8:9], v[36:37] op_sel_hi:[1,0,0] neg_lo:[0,0,1] neg_hi:[0,0,1]
    v_pk_fma_f32 v[66:67], v[66:67], v[8:9], v[36:37] op_sel_hi:[1,0,0] neg_lo:[0,0,1] neg_hi:[0,0,1]
    v_pk_fma_f32 v[68:69], v[68:69], v[8:9], v[36:37] op_sel_hi:[1,0,0] neg_lo:[0,0,1] neg_hi:[0,0,1]
    v_pk_fma_f32 v[70:71], v[70:71], v[8:9], v[36:37] op_sel_hi:[1,0,0] neg_lo:[0,0,1] neg_hi:[0,0,1]
    v_exp_f32 v64, v64
    v_exp_f32 v65, v65
    v_exp_f32 v66, v66
    v_exp_f32 v67, v67
    v_exp_f32 v68, v68
    v_exp_f32 v69, v69
    v_exp_f32 v70, v70
    v_exp_f32 v71, v71
    v_cvt_pk_bf16_f32 v64, v64, v65
    v_cvt_pk_bf16_f32 v65, v66, v67
    v_cvt_pk_bf16_f32 v66, v68, v69
    v_cvt_pk_bf16_f32 v67, v70, v71
    v_pk_fma_f32 v[72:73], v[72:73], v[8:9], v[36:37] op_sel_hi:[1,0,0] neg_lo:[0,0,1] neg_hi:[0,0,1]
    v_pk_fma_f32 v[74:75], v[74:75], v[8:9], v[36:37] op_sel_hi:[1,0,0] neg_lo:[0,0,1] neg_hi:[0,0,1]
    v_pk_fma_f32 v[76:77], v[76:77], v[8:9], v[36:37] op_sel_hi:[1,0,0] neg_lo:[0,0,1] neg_hi:[0,0,1]
    v_pk_fma_f32 v[78:79], v[78:79], v[8:9], v[36:37] op_sel_hi:[1,0,0] neg_lo:[0,0,1] neg_hi:[0,0,1]
    v_exp_f32 v72, v72
    v_exp_f32 v73, v73
    v_exp_f32 v74, v74
    v_exp_f32 v75, v75
    v_exp_f32 v76, v76
    v_exp_f32 v77, v77
    v_exp_f32 v78, v78
    v_exp_f32 v79, v79
    v_cvt_pk_bf16_f32 v72, v72, v73
    v_cvt_pk_bf16_f32 v73, v74, v75
    v_cvt_pk_bf16_f32 v74, v76, v77
    v_cvt_pk_bf16_f32 v75, v78, v79
    v_pk_fma_f32 v[80:81], v[80:81], v[8:9], v[36:37] op_sel_hi:[1,0,0] neg_lo:[0,0,1] neg_hi:[0,0,1]
    v_pk_fma_f32 v[82:83], v[82:83], v[8:9], v[36:37] op_sel_hi:[1,0,0] neg_lo:[0,0,1] neg_hi:[0,0,1]
    v_pk_fma_f32 v[84:85], v[84:85], v[8:9], v[36:37] op_sel_hi:[1,0,0] neg_lo:[0,0,1] neg_hi:[0,0,1]
    v_pk_fma_f32 v[86:87], v[86:87], v[8:9], v[36:37] op_sel_hi:[1,0,0] neg_lo:[0,0,1] neg_hi:[0,0,1]
    v_exp_f32 v80, v80
    v_exp_f32 v81, v81
    v_exp_f32 v82, v82
    v_exp_f32 v83, v83
    v_exp_f32 v84, v84
    v_exp_f32 v85, v85
    v_exp_f32 v86, v86
    v_exp_f32 v87, v87
    v_cvt_pk_bf16_f32 v80, v80, v81
    v_cvt_pk_bf16_f32 v81, v82, v83
    v_cvt_pk_bf16_f32 v82, v84, v85
    v_cvt_pk_bf16_f32 v83, v86, v87
    s_movk_i32 s55, 0x3f80
    s_waitcnt vmcnt(2)
    v_and_or_b32 v252, v10, s55, v252
    v_and_or_b32 v254, v10, s55, v254
    ds_write2st64_b64 v3, v[252:253], v[254:255] offset0:32 offset1:34
    s_waitcnt vmcnt(1)
    v_and_or_b32 v124, v10, s55, v124
    v_and_or_b32 v126, v10, s55, v126
    ds_write2st64_b64 v3, v[124:125], v[126:127] offset0:16 offset1:18
    s_waitcnt vmcnt(0)
    v_and_or_b32 v120, v10, s55, v120
    v_and_or_b32 v122, v10, s55, v122
    ds_write2st64_b64 v3, v[120:121], v[122:123] offset0:0 offset1:2
    s_waitcnt lgkmcnt(0)
    s_barrier
    ds_read_b64_tr_b16 v[108:109], v11 offset:0
    ds_read_b64_tr_b16 v[110:111], v11 offset:1024
    ds_read_b64_tr_b16 v[112:113], v11 offset:512
    ds_read_b64_tr_b16 v[114:115], v11 offset:1536
    ds_read_b64_tr_b16 v[240:241], v11 offset:2048
    ds_read_b64_tr_b16 v[242:243], v11 offset:3072
    ds_read_b64_tr_b16 v[244:245], v11 offset:2560
    ds_read_b64_tr_b16 v[246:247], v11 offset:3584
    v_pk_fma_f32 v[88:89], v[88:89], v[8:9], v[36:37] op_sel_hi:[1,0,0] neg_lo:[0,0,1] neg_hi:[0,0,1]
    v_pk_fma_f32 v[90:91], v[90:91], v[8:9], v[36:37] op_sel_hi:[1,0,0] neg_lo:[0,0,1] neg_hi:[0,0,1]
    v_pk_fma_f32 v[92:93], v[92:93], v[8:9], v[36:37] op_sel_hi:[1,0,0] neg_lo:[0,0,1] neg_hi:[0,0,1]
    v_pk_fma_f32 v[94:95], v[94:95], v[8:9], v[36:37] op_sel_hi:[1,0,0] neg_lo:[0,0,1] neg_hi:[0,0,1]
    v_exp_f32 v88, v88
    v_exp_f32 v89, v89
    v_exp_f32 v90, v90
    v_exp_f32 v91, v91
    v_exp_f32 v92, v92
    v_exp_f32 v93, v93
    v_exp_f32 v94, v94
    v_exp_f32 v95, v95
    v_cvt_pk_bf16_f32 v88, v88, v89
    v_cvt_pk_bf16_f32 v89, v90, v91
    v_cvt_pk_bf16_f32 v90, v92, v93
    v_cvt_pk_bf16_f32 v91, v94, v95
    s_waitcnt lgkmcnt(4)
    v_mfma_f32_16x16x32_bf16 v[120:123], v[108:111], v[40:43], 0
    v_mfma_f32_16x16x32_bf16 v[124:127], v[112:115], v[40:43], 0
    ds_read_b64_tr_b16 v[108:109], v11 offset:4096
    ds_read_b64_tr_b16 v[110:111], v11 offset:5120
    ds_read_b64_tr_b16 v[112:113], v11 offset:4608
    ds_read_b64_tr_b16 v[114:115], v11 offset:5632
    s_waitcnt lgkmcnt(4)
    v_mfma_f32_16x16x32_bf16 v[120:123], v[240:243], v[48:51], v[120:123]
    v_mfma_f32_16x16x32_bf16 v[124:127], v[244:247], v[48:51], v[124:127]
    ds_read_b64_tr_b16 v[240:241], v11 offset:6144
    ds_read_b64_tr_b16 v[242:243], v11 offset:7168
    ds_read_b64_tr_b16 v[244:245], v11 offset:6656
    ds_read_b64_tr_b16 v[246:247], v11 offset:7680
    s_waitcnt lgkmcnt(4)
    v_mfma_f32_16x16x32_bf16 v[120:123], v[108:111], v[56:59], v[120:123]
    v_mfma_f32_16x16x32_bf16 v[124:127], v[112:115], v[56:59], v[124:127]
    ds_read_b64_tr_b16 v[108:109], v11 offset:8192
    ds_read_b64_tr_b16 v[110:111], v11 offset:9216
    ds_read_b64_tr_b16 v[112:113], v11 offset:8704
    ds_read_b64_tr_b16 v[114:115], v11 offset:9728
    v_pk_fma_f32 v[96:97], v[96:97], v[8:9], v[36:37] op_sel_hi:[1,0,0] neg_lo:[0,0,1] neg_hi:[0,0,1]
    v_pk_fma_f32 v[98:99], v[98:99], v[8:9], v[36:37] op_sel_hi:[1,0,0] neg_lo:[0,0,1] neg_hi:[0,0,1]
    v_pk_fma_f32 v[100:101], v[100:101], v[8:9], v[36:37] op_sel_hi:[1,0,0] neg_lo:[0,0,1] neg_hi:[0,0,1]
    v_pk_fma_f32 v[102:103], v[102:103], v[8:9], v[36:37] op_sel_hi:[1,0,0] neg_lo:[0,0,1] neg_hi:[0,0,1]
    v_exp_f32 v96, v96
    v_exp_f32 v97, v97
    v_exp_f32 v98, v98
    v_exp_f32 v99, v99
    v_exp_f32 v100, v100
    v_exp_f32 v101, v101
    v_exp_f32 v102, v102
    v_exp_f32 v103, v103
    v_cvt_pk_bf16_f32 v96, v96, v97
    v_cvt_pk_bf16_f32 v97, v98, v99
    v_cvt_pk_bf16_f32 v98, v100, v101
    v_cvt_pk_bf16_f32 v99, v102, v103
    s_waitcnt lgkmcnt(4)
    v_mfma_f32_16x16x32_bf16 v[120:123], v[240:243], v[64:67], v[120:123]
    v_mfma_f32_16x16x32_bf16 v[124:127], v[244:247], v[64:67], v[124:127]
    ds_read_b64_tr_b16 v[240:241], v11 offset:10240
    ds_read_b64_tr_b16 v[242:243], v11 offset:11264
    ds_read_b64_tr_b16 v[244:245], v11 offset:10752
    ds_read_b64_tr_b16 v[246:247], v11 offset:11776
    s_waitcnt lgkmcnt(4)
    v_mfma_f32_16x16x32_bf16 v[120:123], v[108:111], v[72:75], v[120:123]
    v_mfma_f32_16x16x32_bf16 v[124:127], v[112:115], v[72:75], v[124:127]
    ds_read_b64_tr_b16 v[108:109], v11 offset:12288
    ds_read_b64_tr_b16 v[110:111], v11 offset:13312
    ds_read_b64_tr_b16 v[112:113], v11 offset:12800
    ds_read_b64_tr_b16 v[114:115], v11 offset:13824
    s_waitcnt lgkmcnt(4)
    v_mfma_f32_16x16x32_bf16 v[120:123], v[240:243], v[80:83], v[120:123]
    v_mfma_f32_16x16x32_bf16 v[124:127], v[244:247], v[80:83], v[124:127]
    ds_read_b64_tr_b16 v[240:241], v11 offset:14336
    ds_read_b64_tr_b16 v[242:243], v11 offset:15360
    ds_read_b64_tr_b16 v[244:245], v11 offset:14848
    ds_read_b64_tr_b16 v[246:247], v11 offset:15872
    v_pk_fma_f32 v[104:105], v[104:105], v[8:9], v[36:37] op_sel_hi:[1,0,0] neg_lo:[0,0,1] neg_hi:[0,0,1]
    v_pk_fma_f32 v[106:107], v[106:107], v[8:9], v[36:37] op_sel_hi:[1,0,0] neg_lo:[0,0,1] neg_hi:[0,0,1]
    v_exp_f32 v104, v104
    v_exp_f32 v105, v105
    v_exp_f32 v106, v106
    v_exp_f32 v107, v107
    v_cvt_pk_bf16_f32 v104, v104, v105
    v_cvt_pk_bf16_f32 v105, v106, v107
    s_waitcnt lgkmcnt(4)
    v_mfma_f32_16x16x32_bf16 v[120:123], v[108:111], v[88:91], v[120:123]
    v_mfma_f32_16x16x32_bf16 v[124:127], v[112:115], v[88:91], v[124:127]
    ds_read_b64_tr_b16 v[108:109], v11 offset:16384
    ds_read_b64_tr_b16 v[112:113], v11 offset:16896
    s_waitcnt lgkmcnt(2)
    v_mfma_f32_16x16x32_bf16 v[120:123], v[240:243], v[96:99], v[120:123]
    v_mfma_f32_16x16x32_bf16 v[124:127], v[244:247], v[96:99], v[124:127]
    s_waitcnt lgkmcnt(0)
    v_mfma_f32_16x16x16_bf16 v[120:123], v[108:109], v[104:105], v[120:123]
    v_mfma_f32_16x16x16_bf16 v[124:127], v[112:113], v[104:105], v[124:127]
    s_nop 7
    v_mov_b32 v33, v124
    v_mov_b32 v34, v124
    s_nop 1
    v_permlane32_swap_b32 v33, v34
    v_mov_b32 v33, v34
    v_cmp_lt_u32 vcc, 47, v1
    s_nop 0
    v_permlane16_swap_b32 v33, v34
    v_rcp_f32 v34, v34
    s_nop 0
    v_cndmask_b32_e64 v33, v34, 0, vcc
    v_mul_f32 v120, v120, v34
    v_mul_f32 v121, v121, v34
    v_mul_f32 v122, v122, v34
    v_mul_f32 v123, v123, v34
    v_mul_f32 v124, v124, v33
    v_mul_f32 v125, v125, v33
    v_mul_f32 v126, v126, v33
    v_mul_f32 v127, v127, v33
    v_cvt_pk_bf16_f32 v120, v120, v121
    v_cvt_pk_bf16_f32 v121, v122, v123
    v_cvt_pk_bf16_f32 v122, v124, v125
    v_cvt_pk_bf16_f32 v123, v126, v127
    buffer_store_dwordx4 v[120:123], v2, s[28:31], s1 offen sc1
    s_lshl_b32 s54, s43, 7
    s_sub_u32 s96, s96, s54
    s_cmp_eq_u32 s91, 2
    s_cbranch_scc1 L_gate
    ds_read_b64_tr_b16 v[72:73], v15 offset:32768
    ds_read_b64_tr_b16 v[74:75], v15 offset:33280
    ds_read_b64_tr_b16 v[76:77], v18 offset:32768
    ds_read_b64_tr_b16 v[78:79], v18 offset:33280
    ds_read_b64_tr_b16 v[80:81], v15 offset:36864
    ds_read_b64_tr_b16 v[82:83], v15 offset:37376
    ds_read_b64_tr_b16 v[84:85], v18 offset:36864
    ds_read_b64_tr_b16 v[86:87], v18 offset:37376
    s_and_b32 s54, s40, 3
    s_lshr_b32 s55, s40, 2
    s_mul_i32 s54, s54, 144
    s_add_u32 s54, s54, s55
    s_mul_i32 s55, s42, 576
    s_add_u32 s54, s54, s55
    s_lshl_b32 s54, s54, 10
    s_add_u32 s54, s54, 8443904
    v_add_u32 v60, s54, v2
    v_add_u32 v61, 73728, v60
    s_waitcnt lgkmcnt(0)
    v_mfma_f32_16x16x32_bf16 v[112:115], v[72:75], v[128:131], 0
    ds_read_b64_tr_b16 v[88:89], v15 offset:40960
    ds_read_b64_tr_b16 v[90:91], v15 offset:41472
    v_mfma_f32_16x16x32_bf16 v[116:119], v[76:79], v[128:131], 0
    ds_read_b64_tr_b16 v[92:93], v18 offset:40960
    ds_read_b64_tr_b16 v[94:95], v18 offset:41472
    v_mfma_f32_16x16x32_bf16 v[120:123], v[72:75], v[184:187], 0
    ds_read_b64_tr_b16 v[96:97], v15 offset:45056
    ds_read_b64_tr_b16 v[98:99], v15 offset:45568
    v_mfma_f32_16x16x32_bf16 v[124:127], v[76:79], v[184:187], 0
    ds_read_b64_tr_b16 v[100:101], v18 offset:45056
    ds_read_b64_tr_b16 v[102:103], v18 offset:45568
    v_mfma_f32_16x16x32_bf16 v[112:115], v[80:83], v[132:135], v[112:115]
    v_mfma_f32_16x16x32_bf16 v[116:119], v[84:87], v[132:135], v[116:119]
    v_mfma_f32_16x16x32_bf16 v[120:123], v[80:83], v[188:191], v[120:123]
    v_mfma_f32_16x16x32_bf16 v[124:127], v[84:87], v[188:191], v[124:127]
    s_waitcnt lgkmcnt(0)
    v_mfma_f32_16x16x32_bf16 v[112:115], v[88:91], v[136:139], v[112:115]
    ds_read_b64_tr_b16 v[72:73], v15 offset:49152
    ds_read_b64_tr_b16 v[74:75], v15 offset:49664
    v_mfma_f32_16x16x32_bf16 v[116:119], v[92:95], v[136:139], v[116:119]
    ds_read_b64_tr_b16 v[76:77], v18 offset:49152
    ds_read_b64_tr_b16 v[78:79], v18 offset:49664
    v_mfma_f32_16x16x32_bf16 v[120:123], v[88:91], v[192:195], v[120:123]
    ds_read_b64_tr_b16 v[80:81], v15 offset:53248
    ds_read_b64_tr_b16 v[82:83], v15 offset:53760
    v_mfma_f32_16x16x32_bf16 v[124:127], v[92:95], v[192:195], v[124:127]
    ds_read_b64_tr_b16 v[84:85], v18 offset:53248
    ds_read_b64_tr_b16 v[86:87], v18 offset:53760
    v_mfma_f32_16x16x32_bf16 v[112:115], v[96:99], v[140:143], v[112:115]
    v_mfma_f32_16x16x32_bf16 v[116:119], v[100:103], v[140:143], v[116:119]
    v_mfma_f32_16x16x32_bf16 v[120:123], v[96:99], v[196:199], v[120:123]
    v_mfma_f32_16x16x32_bf16 v[124:127], v[100:103], v[196:199], v[124:127]
    s_waitcnt lgkmcnt(0)
    v_mfma_f32_16x16x32_bf16 v[112:115], v[72:75], v[144:147], v[112:115]
    ds_read_b64_tr_b16 v[88:89], v15 offset:57344
    ds_read_b64_tr_b16 v[90:91], v15 offset:57856
    v_mfma_f32_16x16x32_bf16 v[116:119], v[76:79], v[144:147], v[116:119]
    ds_read_b64_tr_b16 v[92:93], v18 offset:57344
    ds_read_b64_tr_b16 v[94:95], v18 offset:57856
    v_mfma_f32_16x16x32_bf16 v[120:123], v[72:75], v[200:203], v[120:123]
    ds_read_b64_tr_b16 v[96:97], v15 offset:61440
    ds_read_b64_tr_b16 v[98:99], v15 offset:61952
    v_mfma_f32_16x16x32_bf16 v[124:127], v[76:79], v[200:203], v[124:127]
    ds_read_b64_tr_b16 v[100:101], v18 offset:61440
    ds_read_b64_tr_b16 v[102:103], v18 offset:61952
    v_mfma_f32_16x16x32_bf16 v[112:115], v[80:83], v[148:151], v[112:115]
    v_mfma_f32_16x16x32_bf16 v[116:119], v[84:87], v[148:151], v[116:119]
    v_mfma_f32_16x16x32_bf16 v[120:123], v[80:83], v[204:207], v[120:123]
    v_mfma_f32_16x16x32_bf16 v[124:127], v[84:87], v[204:207], v[124:127]
    s_waitcnt vmcnt(0)
    s_barrier
    buffer_store_dword v39, v38, s[28:31], s5 offen offset:0 sc1
    s_waitcnt lgkmcnt(0)
    v_mfma_f32_16x16x32_bf16 v[112:115], v[88:91], v[152:155], v[112:115]
    ds_read_b64_tr_b16 v[72:73], v16 offset:0
    ds_read_b64_tr_b16 v[74:75], v16 offset:512
    v_mfma_f32_16x16x32_bf16 v[116:119], v[92:95], v[152:155], v[116:119]
    ds_read_b64_tr_b16 v[76:77], v19 offset:0
    ds_read_b64_tr_b16 v[78:79], v19 offset:512
    v_mfma_f32_16x16x32_bf16 v[120:123], v[88:91], v[208:211], v[120:123]
    ds_read_b64_tr_b16 v[80:81], v16 offset:4096
    ds_read_b64_tr_b16 v[82:83], v16 offset:4608
    v_mfma_f32_16x16x32_bf16 v[124:127], v[92:95], v[208:211], v[124:127]
    ds_read_b64_tr_b16 v[84:85], v19 offset:4096
    ds_read_b64_tr_b16 v[86:87], v19 offset:4608
    v_mfma_f32_16x16x32_bf16 v[112:115], v[96:99], v[156:159], v[112:115]
    v_mfma_f32_16x16x32_bf16 v[116:119], v[100:103], v[156:159], v[116:119]
    v_mfma_f32_16x16x32_bf16 v[120:123], v[96:99], v[212:215], v[120:123]
    v_mfma_f32_16x16x32_bf16 v[124:127], v[100:103], v[212:215], v[124:127]
    s_waitcnt lgkmcnt(0)
    v_mfma_f32_16x16x32_bf16 v[112:115], v[72:75], v[160:163], v[112:115]
    ds_read_b64_tr_b16 v[88:89], v16 offset:8192
    ds_read_b64_tr_b16 v[90:91], v16 offset:8704
    v_mfma_f32_16x16x32_bf16 v[116:119], v[76:79], v[160:163], v[116:119]
    ds_read_b64_tr_b16 v[92:93], v19 offset:8192
    ds_read_b64_tr_b16 v[94:95], v19 offset:8704
    v_mfma_f32_16x16x32_bf16 v[120:123], v[72:75], v[216:219], v[120:123]
    ds_read_b64_tr_b16 v[96:97], v16 offset:12288
    ds_read_b64_tr_b16 v[98:99], v16 offset:12800
    v_mfma_f32_16x16x32_bf16 v[124:127], v[76:79], v[216:219], v[124:127]
    ds_read_b64_tr_b16 v[100:101], v19 offset:12288
    ds_read_b64_tr_b16 v[102:103], v19 offset:12800
    v_mfma_f32_16x16x32_bf16 v[112:115], v[80:83], v[164:167], v[112:115]
    v_mfma_f32_16x16x32_bf16 v[116:119], v[84:87], v[164:167], v[116:119]
    v_mfma_f32_16x16x32_bf16 v[120:123], v[80:83], v[220:223], v[120:123]
    v_mfma_f32_16x16x32_bf16 v[124:127], v[84:87], v[220:223], v[124:127]
    s_waitcnt lgkmcnt(0)
    v_mfma_f32_16x16x32_bf16 v[112:115], v[88:91], v[168:171], v[112:115]
    ds_read_b64_tr_b16 v[72:73], v16 offset:16384
    ds_read_b64_tr_b16 v[74:75], v16 offset:16896
    v_mfma_f32_16x16x32_bf16 v[116:119], v[92:95], v[168:171], v[116:119]
    ds_read_b64_tr_b16 v[76:77], v19 offset:16384
    ds_read_b64_tr_b16 v[78:79], v19 offset:16896
    v_mfma_f32_16x16x32_bf16 v[120:123], v[88:91], v[224:227], v[120:123]
    ds_read_b64_tr_b16 v[80:81], v16 offset:20480
    ds_read_b64_tr_b16 v[82:83], v16 offset:20992
    v_mfma_f32_16x16x32_bf16 v[124:127], v[92:95], v[224:227], v[124:127]
    ds_read_b64_tr_b16 v[84:85], v19 offset:20480
    ds_read_b64_tr_b16 v[86:87], v19 offset:20992
    v_mfma_f32_16x16x32_bf16 v[112:115], v[96:99], v[172:175], v[112:115]
    v_mfma_f32_16x16x32_bf16 v[116:119], v[100:103], v[172:175], v[116:119]
    v_mfma_f32_16x16x32_bf16 v[120:123], v[96:99], v[228:231], v[120:123]
    v_mfma_f32_16x16x32_bf16 v[124:127], v[100:103], v[228:231], v[124:127]
    s_waitcnt lgkmcnt(0)
    v_mfma_f32_16x16x32_bf16 v[112:115], v[72:75], v[176:179], v[112:115]
    v_mfma_f32_16x16x32_bf16 v[116:119], v[76:79], v[176:179], v[116:119]
    v_mfma_f32_16x16x32_bf16 v[120:123], v[72:75], v[232:235], v[120:123]
    v_mfma_f32_16x16x32_bf16 v[124:127], v[76:79], v[232:235], v[124:127]
    v_mfma_f32_16x16x32_bf16 v[112:115], v[80:83], v[180:183], v[112:115]
    v_mfma_f32_16x16x32_bf16 v[116:119], v[84:87], v[180:183], v[116:119]
    v_mfma_f32_16x16x32_bf16 v[120:123], v[80:83], v[236:239], v[120:123]
    v_mfma_f32_16x16x32_bf16 v[124:127], v[84:87], v[236:239], v[124:127]
    s_nop 4
    v_cvt_pk_bf16_f32 v104, v112, v113
    v_cvt_pk_bf16_f32 v105, v114, v115
    v_pk_max_i16 v104, v104, 0
    v_pk_max_i16 v105, v105, 0
    v_cvt_pk_bf16_f32 v106, v116, v117
    v_cvt_pk_bf16_f32 v107, v118, v119
    v_pk_max_i16 v106, v106, 0
    v_pk_max_i16 v107, v107, 0
    buffer_store_dwordx4 v[104:107], v60, s[28:31], 0 offen sc1
    v_cvt_pk_bf16_f32 v108, v120, v121
    v_cvt_pk_bf16_f32 v109, v122, v123
    v_pk_max_i16 v108, v108, 0
    v_pk_max_i16 v109, v109, 0
    v_cvt_pk_bf16_f32 v110, v124, v125
    v_cvt_pk_bf16_f32 v111, v126, v127
    v_pk_max_i16 v110, v110, 0
    v_pk_max_i16 v111, v111, 0
    buffer_store_dwordx4 v[108:111], v61, s[28:31], 0 offen sc1
    s_waitcnt vmcnt(0)
    s_barrier
    s_add_u32 s55, s96, 6144
    buffer_store_dword v39, v38, s[28:31], s55 offen offset:0 sc1
    s_branch L_fin
L_gate:
    v_lshrrev_b32 v33, 4, v1
    v_lshlrev_b32 v33, 4, v33
    buffer_load_dwordx4 v[40:43], v33, s[24:27], s45 offen offset:0
    buffer_load_dwordx4 v[44:47], v33, s[24:27], s45 offen offset:64
    buffer_load_dwordx4 v[48:51], v33, s[24:27], s46 offen offset:0
    buffer_load_dwordx4 v[52:55], v33, s[24:27], s46 offen offset:64
    buffer_load_dwordx4 v[56:59], v33, s[24:27], s47 offen offset:0
    buffer_load_dwordx4 v[60:63], v33, s[24:27], s47 offen offset:64
    buffer_load_dwordx4 v[64:67], v33, s[24:27], s48 offen offset:0
    buffer_load_dwordx4 v[68:71], v33, s[24:27], s48 offen offset:64
    buffer_load_dwordx4 v[72:75], v33, s[24:27], s49 offen offset:0
    buffer_load_dwordx4 v[76:79], v33, s[24:27], s49 offen offset:64
    buffer_load_dwordx4 v[80:83], v33, s[24:27], s50 offen offset:0
    buffer_load_dwordx4 v[84:87], v33, s[24:27], s50 offen offset:64
    buffer_load_dwordx4 v[88:91], v33, s[24:27], s51 offen offset:0
    buffer_load_dwordx4 v[92:95], v33, s[24:27], s51 offen offset:64
    s_waitcnt vmcnt(14)
    s_barrier
    buffer_store_dword v39, v38, s[28:31], s5 offen offset:0 sc1
    s_waitcnt vmcnt(1)
    v_mfma_f32_16x16x32_bf16 v[112:115], v[40:43], v[128:131], 0
    v_mfma_f32_16x16x32_bf16 v[112:115], v[44:47], v[132:135], v[112:115]
    v_mfma_f32_16x16x32_bf16 v[112:115], v[48:51], v[136:139], v[112:115]
    v_mfma_f32_16x16x32_bf16 v[112:115], v[52:55], v[140:143], v[112:115]
    v_mfma_f32_16x16x32_bf16 v[112:115], v[56:59], v[144:147], v[112:115]
    v_mfma_f32_16x16x32_bf16 v[112:115], v[60:63], v[148:151], v[112:115]
    v_mfma_f32_16x16x32_bf16 v[112:115], v[64:67], v[152:155], v[112:115]
    v_mfma_f32_16x16x32_bf16 v[112:115], v[68:71], v[156:159], v[112:115]
    v_mfma_f32_16x16x32_bf16 v[112:115], v[72:75], v[160:163], v[112:115]
    v_mfma_f32_16x16x32_bf16 v[112:115], v[76:79], v[164:167], v[112:115]
    v_mfma_f32_16x16x32_bf16 v[112:115], v[80:83], v[168:171], v[112:115]
    v_mfma_f32_16x16x32_bf16 v[112:115], v[84:87], v[172:175], v[112:115]
    v_mfma_f32_16x16x32_bf16 v[112:115], v[88:91], v[176:179], v[112:115]
    v_mfma_f32_16x16x32_bf16 v[112:115], v[92:95], v[180:183], v[112:115]
    v_mfma_f32_16x16x32_bf16 v[116:119], v[40:43], v[184:187], 0
    v_mfma_f32_16x16x32_bf16 v[116:119], v[44:47], v[188:191], v[116:119]
    v_mfma_f32_16x16x32_bf16 v[116:119], v[48:51], v[192:195], v[116:119]
    v_mfma_f32_16x16x32_bf16 v[116:119], v[52:55], v[196:199], v[116:119]
    v_mfma_f32_16x16x32_bf16 v[116:119], v[56:59], v[200:203], v[116:119]
    v_mfma_f32_16x16x32_bf16 v[116:119], v[60:63], v[204:207], v[116:119]
    v_mfma_f32_16x16x32_bf16 v[116:119], v[64:67], v[208:211], v[116:119]
    v_mfma_f32_16x16x32_bf16 v[116:119], v[68:71], v[212:215], v[116:119]
    v_mfma_f32_16x16x32_bf16 v[116:119], v[72:75], v[216:219], v[116:119]
    v_mfma_f32_16x16x32_bf16 v[116:119], v[76:79], v[220:223], v[116:119]
    v_mfma_f32_16x16x32_bf16 v[116:119], v[80:83], v[224:227], v[116:119]
    v_mfma_f32_16x16x32_bf16 v[116:119], v[84:87], v[228:231], v[116:119]
    v_mfma_f32_16x16x32_bf16 v[116:119], v[88:91], v[232:235], v[116:119]
    v_mfma_f32_16x16x32_bf16 v[116:119], v[92:95], v[236:239], v[116:119]
    v_cmp_gt_u32 vcc, 16, v1
    s_nop 6
    v_cndmask_b32 v33, v116, v112, vcc
    v_cvt_pk_bf16_f32 v33, v33, v33
    v_lshlrev_b32 v33, 16, v33
    v_mul_f32 v33, 0xbfb8aa3b, v33
    v_exp_f32 v33, v33
    s_nop 0
    v_add_f32 v33, 1.0, v33
    v_rcp_f32 v33, v33
    s_nop 0
    v_cvt_pk_bf16_f32 v33, v33, v33
    v_lshlrev_b32 v33, 16, v33
    v_lshlrev_b32 v34, 2, v1
    s_lshl_b32 s54, s42, 2
    s_and_b32 s55, s40, 3
    s_add_u32 s54, s54, s55
    s_lshl_b32 s54, s54, 7
    s_add_u32 s54, s54, 196608
    s_mov_b32 exec_hi, 0
    buffer_store_dword v33, v34, s[28:31], s54 offen sc1
    s_mov_b64 exec, -1
    s_waitcnt vmcnt(0)
    s_barrier
    s_add_u32 s55, s96, 6272
    buffer_store_dword v39, v38, s[28:31], s55 offen offset:0 sc1
    s_cmp_lg_u32 s2, 255
    s_cbranch_scc1 L_fin
    s_cmp_lg_u32 s40, 7
    s_cbranch_scc1 L_fin
    v_lshrrev_b32 v33, 2, v1
    v_lshlrev_b32 v33, 13, v33
    v_and_b32 v34, 3, v1
    v_lshl_add_u32 v33, v34, 9, v33
    v_add_u32 v33, 4096, v33
    s_mov_b32 s94, 40000
L_epo_loop:
    buffer_load_dword v40, v33, s[28:31], 0 offen offset:0 sc1
    buffer_load_dword v41, v33, s[28:31], 0 offen offset:128 sc1
    buffer_load_dword v42, v33, s[28:31], 0 offen offset:256 sc1
    buffer_load_dword v43, v33, s[28:31], 0 offen offset:384 sc1
    s_waitcnt vmcnt(0)
    v_xor_b32 v40, v40, v39
    v_xor_b32 v41, v41, v39
    v_xor_b32 v42, v42, v39
    v_xor_b32 v43, v43, v39
    v_or3_b32 v40, v40, v41, v42
    v_or_b32 v40, v40, v43
    v_cmp_ne_u32 vcc, 0, v40
    s_sub_u32 s94, s94, 1
    s_cbranch_scc1 L_epo_skip
    s_cmp_lg_u64 vcc, 0
    s_cbranch_scc1 L_epo_loop
L_epo_skip:
    s_add_u32 s54, s95, 1
    v_mov_b32 v33, s54
    buffer_store_dword v33, v38, s[28:31], 0 offen offset:0 sc1
    s_branch L_fin
L_pq_slow:
    s_mov_b32 s94, 40000
    s_mov_b64 exec, 0xff
L_pq_loop:
    buffer_load_dword v52, v14, s[28:31], 0 offen sc1
    s_waitcnt vmcnt(0)
    v_cmp_ne_u32 vcc, s53, v52
    s_sub_u32 s94, s94, 1
    s_cbranch_scc1 L_pq_out
    s_cmp_lg_u32 vcc_lo, 0
    s_cbranch_scc1 L_pq_loop
L_pq_out:
    s_mov_b64 exec, -1
    s_branch L_pq_back
L_pv_slow:
    s_mov_b32 s94, 40000
    s_mov_b64 exec, 0x3f00
L_pv_loop:
    buffer_load_dword v5, v14, s[28:31], 0 offen sc1
    s_waitcnt vmcnt(0)
    v_cmp_ne_u32 vcc, s53, v5
    s_sub_u32 s94, s94, 1
    s_cbranch_scc1 L_pv_out
    s_cmp_lg_u32 vcc_lo, 0
    s_cbranch_scc1 L_pv_loop
L_pv_out:
    s_mov_b64 exec, -1
    s_branch L_pv_back
L_pe_slow:
    s_mov_b32 s94, 40000
    s_mov_b64 exec, 0x3ff
L_pe_loop:
    buffer_load_dword v6, v12, s[28:31], 0 offen sc1
    s_waitcnt vmcnt(0)
    v_cmp_ne_u32 vcc, s53, v6
    s_sub_u32 s94, s94, 1
    s_cbranch_scc1 L_pe_out
    s_cmp_lg_u32 vcc_lo, 0
    s_cbranch_scc1 L_pe_loop
L_pe_out:
    s_mov_b64 exec, -1
    s_branch L_pe_back
L_pl_slow:
    s_mov_b32 s94, 40000
    s_mov_b64 exec, 0x3fffc00
L_pl_loop:
    buffer_load_dword v116, v12, s[28:31], 0 offen sc1
    s_waitcnt vmcnt(0)
    v_cmp_ne_u32 vcc, s53, v116
    s_sub_u32 s94, s94, 1
    s_cbranch_scc1 L_pl_out
    s_cmp_lg_u32 vcc_lo, 0
    s_cbranch_scc1 L_pl_loop
L_pl_out:
    s_mov_b64 exec, -1
    s_branch L_pl_back
L_po_slow:
    s_mov_b32 s94, 40000
    s_mov_b64 exec, 0xffff
L_po_loop:
    buffer_load_dword v107, v104, s[28:31], 0 offen sc1
    s_waitcnt vmcnt(0)
    v_cmp_ne_u32 vcc, s53, v107
    s_sub_u32 s94, s94, 1
    s_cbranch_scc1 L_po_out
    s_cmp_lg_u32 vcc_lo, 0
    s_cbranch_scc1 L_po_loop
L_po_out:
    s_mov_b64 exec, -1
    s_branch L_po_back
L_pt_slow:
    s_mov_b32 s94, 40000
    s_mov_b64 exec, 0x1c000000
L_pt_loop:
    buffer_load_dword v108, v12, s[28:31], 0 offen sc1
    s_waitcnt vmcnt(0)
    v_cmp_ne_u32 vcc, s53, v108
    s_sub_u32 s94, s94, 1
    s_cbranch_scc1 L_pt_out
    s_cmp_lg_u32 vcc_lo, 0
    s_cbranch_scc1 L_pt_loop
L_pt_out:
    s_mov_b64 exec, -1
    s_branch L_pt_back
L_pvh_slow:
    s_mov_b32 s94, 40000
    s_mov_b64 exec, 0x3f00
L_pvh_loop:
    buffer_load_dword v5, v14, s[28:31], 0 offen sc1
    s_waitcnt vmcnt(0)
    v_cmp_ne_u32 vcc, s53, v5
    s_sub_u32 s94, s94, 1
    s_cbranch_scc1 L_pvh_out
    s_cmp_lg_u32 vcc_lo, 0
    s_cbranch_scc1 L_pvh_loop
L_pvh_out:
    s_mov_b64 exec, -1
    s_branch L_pvh_back
L_code_end:
.section .rodata,"a"
.p2align 6
.amdhsa_kernel gated_mix__sliding_block__dense_activation_relu__prompt_kernel
  .amdhsa_next_free_vgpr 256
  .amdhsa_next_free_sgpr 102
  .amdhsa_accum_offset 256
  .amdhsa_group_segment_fixed_size 0
  .amdhsa_kernarg_size 80
  .amdhsa_user_sgpr_count 2
  .amdhsa_user_sgpr_kernarg_segment_ptr 1
  .amdhsa_system_sgpr_workgroup_id_x 1
.end_amdhsa_kernel
```
